```python
import torch

def _softmax(x, axis=-1):
    return torch.softmax(x, dim=axis)
def _gelu(x):
    return torch.nn.functional.gelu(x, approximate="tanh")
def _silu(x):
    return torch.nn.functional.silu(x)
def _sigmoid(x):
    return torch.sigmoid(x)
def _layernorm(x, axis=-1, eps=1e-5):
    m = x.mean(dim=axis, keepdim=True)
    v = x.var(dim=axis, keepdim=True, unbiased=False)
    return (x - m) / torch.sqrt(v + eps)
def _scatter_add(tgt, idx, src, axis=0):
    return tgt.clone().index_add_(axis, idx, src)
def _segment_sum(src, seg, n):
    out = torch.zeros((n,) + src.shape[1:], dtype=src.dtype)
    return out.index_add_(0, seg, src)
def _pad(x, pw):
    flat = tuple(v for pair in reversed(pw) for v in pair)
    return torch.nn.functional.pad(x, flat)

kernel_name = 'parallel_sum__sliding_block_cached__dense_activation_gelu__decode'

def setup_inputs():

    _w = (lambda a: (lambda t: t.to(torch.bfloat16) if t.is_floating_point() else t)(torch.as_tensor(a)))
    def _A_setup():
        B, Sq, D = 8, 1, 512
        Hq, Hkv, Sk, Dh = 32, 8, 4096, 128
        assert Hq % Hkv == 0, (Hq, Hkv)
        return {
            "x": _w((lambda *s: torch.randn(*s, dtype=torch.bfloat16) * 0.05)(B, Sq, D)),
            "k_cache": _w((lambda *s: torch.randn(*s, dtype=torch.bfloat16) * 3.2)(B, Hkv, Sk, Dh)),
            "v_cache": _w((lambda *s: torch.randn(*s, dtype=torch.bfloat16) * 0.8)(B, Hkv, Sk, Dh)),
            "wq": _w((lambda *s: torch.randn(*s, dtype=torch.bfloat16) * 3.2)(D, Hq * Dh) * (D ** -0.5)),
            "wo": _w((lambda *s: torch.randn(*s, dtype=torch.bfloat16) * 0.8)(Hq * Dh, D) * ((Hq * Dh) ** -0.5)),
        }
    _A_in = _A_setup()

    def _B_setup():
        B, S, D, F = 8, 1, 512, 1792
        return {
            "x": _w((lambda *s: torch.randn(*s, dtype=torch.bfloat16) * 0.05)(B, S, D)),
            "w1": _w((lambda *s: torch.randn(*s, dtype=torch.bfloat16) * 3.2)(D, F) * (D ** -0.5)),
            "b1": _w((lambda *s: torch.randn(*s, dtype=torch.bfloat16) * 3.2)(F) * 0.01),
            "w2": _w((lambda *s: torch.randn(*s, dtype=torch.bfloat16) * 0.4)(F, D) * (F ** -0.5)),
            "b2": _w((lambda *s: torch.randn(*s, dtype=torch.bfloat16) * 0.4)(D) * 0.01),
        }
    _B_in = _B_setup()

    return {
        "A_x": _A_in["x"],
        "A_k_cache": _A_in["k_cache"],
        "A_v_cache": _A_in["v_cache"],
        "A_wq": _A_in["wq"],
        "A_wo": _A_in["wo"],
        "B_x": _B_in["x"],
        "B_w1": _B_in["w1"],
        "B_b1": _B_in["b1"],
        "B_w2": _B_in["w2"],
        "B_b2": _B_in["b2"],
    }

def reference(A_x, A_k_cache, A_v_cache, A_wq, A_wo, B_x, B_w1, B_b1, B_w2, B_b2):
    def _A_ref(x, k_cache, v_cache, wq, wo):
        B, Sq, D = x.shape
        Hq, Dh = 32, 128
        Hkv, Sk = k_cache.shape[1], k_cache.shape[2]
        W = min(4096, max(256, Sk // 4))
        rep = Hq // Hkv
        q = (lambda x, *d: x.permute(*d))((x @ wq).reshape(B, Sq, Hq, Dh), 0, 2, 1, 3)
        k = (lambda x, n, axis: torch.repeat_interleave(x, n, dim=axis))(k_cache[:, :, Sk - W:, :], rep, axis=1)
        v = (lambda x, n, axis: torch.repeat_interleave(x, n, dim=axis))(v_cache[:, :, Sk - W:, :], rep, axis=1)
        scores = torch.einsum("bhqd,bhkd->bhqk", q, k) * (Dh ** -0.5)
        p = _softmax(scores, axis=-1)
        o = torch.einsum("bhqk,bhkd->bhqd", p, v)
        return (lambda x, *d: x.permute(*d))(o, 0, 2, 1, 3).reshape(B, Sq, Hq * Dh) @ wo

    def _B_ref(x, w1, b1, w2, b2):
        h = torch.einsum("bsd,df->bsf", x, w1) + b1
        h = _gelu(h)
        return torch.einsum("bsf,fd->bsd", h, w2) + b2

    x = A_x
    xn = _layernorm(x, axis=-1)
    return x + _A_ref(xn, A_k_cache, A_v_cache, A_wq, A_wo) + _B_ref(xn, B_w1, B_b1, B_w2, B_b2)
```

```asm
; @launch kernel=k1_kernel grid=(184,1,1) block=(256,1,1) lds=33792
; @launch kernel=k2_kernel grid=(512,1,1) block=(256,1,1) lds=36864
; @launch kernel=k3_kernel grid=(368,1,1) block=(256,1,1) lds=20480
; @launch kernel=k4_kernel grid=(16,1,1) block=(256,1,1) lds=0
.amdgcn_target "amdgcn-amd-amdhsa--gfx950"
.text
.globl k1_kernel
.p2align 8
.type k1_kernel,@function
k1_kernel:
    s_cmp_ge_u32 s2, 184
    s_cbranch_scc1 K1_END
    s_load_dwordx2 s[4:5], s[0:1], 0
    s_load_dwordx2 s[6:7], s[0:1], 24
    s_load_dwordx4 s[24:27], s[0:1], 48
    s_load_dwordx2 s[28:29], s[0:1], 96
    v_and_b32 v1, 63, v0
    v_lshrrev_b32 v2, 6, v0
    s_waitcnt lgkmcnt(0)
    s_mov_b32 s8, s4
    s_mov_b32 s9, s5
    s_mov_b32 s10, 8192
    s_mov_b32 s11, 0x00020000
    s_sub_u32 s31, s2, 128
    s_cmp_ge_u32 s2, 128
    s_cselect_b32 s12, s24, s6
    s_cselect_b32 s13, s25, s7
    s_mov_b32 s14, 4194304
    s_cselect_b32 s14, 1835008, s14
    s_mov_b32 s15, 0x00020000
    s_mov_b32 s30, 8192
    s_cselect_b32 s30, 3584, s30
    s_cselect_b32 s31, s31, s2
    s_lshl_b32 s31, s31, 6
    s_mov_b32 s16, s28
    s_mov_b32 s17, s29
    s_mov_b32 s18, 268435456
    s_mov_b32 s19, 0x00020000
    s_mov_b32 s20, s26
    s_mov_b32 s21, s27
    s_mov_b32 s22, 3584
    s_mov_b32 s23, 0x00020000
    v_lshrrev_b32 v3, 4, v1
    v_lshl_add_u32 v3, v2, 7, v3
    v_mul_lo_u32 v3, v3, s30
    v_and_b32 v4, 15, v1
    v_lshl_add_u32 v3, v4, 2, v3
    v_add_u32 v3, s31, v3
    s_lshl_b32 s30, s30, 2
    s_mov_b32 s32, 0
    buffer_load_dword v64, v3, s[12:15], s32 offen
    s_add_u32 s32, s32, s30
    buffer_load_dword v65, v3, s[12:15], s32 offen
    s_add_u32 s32, s32, s30
    buffer_load_dword v66, v3, s[12:15], s32 offen
    s_add_u32 s32, s32, s30
    buffer_load_dword v67, v3, s[12:15], s32 offen
    s_add_u32 s32, s32, s30
    buffer_load_dword v68, v3, s[12:15], s32 offen
    s_add_u32 s32, s32, s30
    buffer_load_dword v69, v3, s[12:15], s32 offen
    s_add_u32 s32, s32, s30
    buffer_load_dword v70, v3, s[12:15], s32 offen
    s_add_u32 s32, s32, s30
    buffer_load_dword v71, v3, s[12:15], s32 offen
    s_add_u32 s32, s32, s30
    buffer_load_dword v72, v3, s[12:15], s32 offen
    s_add_u32 s32, s32, s30
    buffer_load_dword v73, v3, s[12:15], s32 offen
    s_add_u32 s32, s32, s30
    buffer_load_dword v74, v3, s[12:15], s32 offen
    s_add_u32 s32, s32, s30
    buffer_load_dword v75, v3, s[12:15], s32 offen
    s_add_u32 s32, s32, s30
    buffer_load_dword v76, v3, s[12:15], s32 offen
    s_add_u32 s32, s32, s30
    buffer_load_dword v77, v3, s[12:15], s32 offen
    s_add_u32 s32, s32, s30
    buffer_load_dword v78, v3, s[12:15], s32 offen
    s_add_u32 s32, s32, s30
    buffer_load_dword v79, v3, s[12:15], s32 offen
    s_add_u32 s32, s32, s30
    buffer_load_dword v80, v3, s[12:15], s32 offen
    s_add_u32 s32, s32, s30
    buffer_load_dword v81, v3, s[12:15], s32 offen
    s_add_u32 s32, s32, s30
    buffer_load_dword v82, v3, s[12:15], s32 offen
    s_add_u32 s32, s32, s30
    buffer_load_dword v83, v3, s[12:15], s32 offen
    s_add_u32 s32, s32, s30
    buffer_load_dword v84, v3, s[12:15], s32 offen
    s_add_u32 s32, s32, s30
    buffer_load_dword v85, v3, s[12:15], s32 offen
    s_add_u32 s32, s32, s30
    buffer_load_dword v86, v3, s[12:15], s32 offen
    s_add_u32 s32, s32, s30
    buffer_load_dword v87, v3, s[12:15], s32 offen
    s_add_u32 s32, s32, s30
    buffer_load_dword v88, v3, s[12:15], s32 offen
    s_add_u32 s32, s32, s30
    buffer_load_dword v89, v3, s[12:15], s32 offen
    s_add_u32 s32, s32, s30
    buffer_load_dword v90, v3, s[12:15], s32 offen
    s_add_u32 s32, s32, s30
    buffer_load_dword v91, v3, s[12:15], s32 offen
    s_add_u32 s32, s32, s30
    buffer_load_dword v92, v3, s[12:15], s32 offen
    s_add_u32 s32, s32, s30
    buffer_load_dword v93, v3, s[12:15], s32 offen
    s_add_u32 s32, s32, s30
    buffer_load_dword v94, v3, s[12:15], s32 offen
    s_add_u32 s32, s32, s30
    buffer_load_dword v95, v3, s[12:15], s32 offen
    v_lshlrev_b32 v5, 11, v2
    v_lshl_add_u32 v5, v1, 4, v5
    buffer_load_dwordx4 v[8:11], v5, s[8:11], 0 offen
    buffer_load_dwordx4 v[12:15], v5, s[8:11], 0 offen offset:1024
    s_waitcnt vmcnt(0)
    v_mul_u32_u24 v6, 272, v1
    v_lshl_add_u32 v6, v2, 3, v6
    v_lshlrev_b32 v16, 16, v8
    v_and_b32 v17, 0xffff0000, v8
    v_lshlrev_b32 v18, 16, v9
    v_and_b32 v19, 0xffff0000, v9
    v_lshlrev_b32 v20, 16, v10
    v_and_b32 v21, 0xffff0000, v10
    v_lshlrev_b32 v22, 16, v11
    v_and_b32 v23, 0xffff0000, v11
    v_add_f32 v24, v16, v17
    v_add_f32 v24, v24, v18
    v_add_f32 v24, v24, v19
    v_add_f32 v24, v24, v20
    v_add_f32 v24, v24, v21
    v_add_f32 v24, v24, v22
    v_add_f32 v24, v24, v23
    s_nop 1
    v_add_f32_dpp v24, v24, v24 row_shr:1 row_mask:0xf bank_mask:0xf
    s_nop 1
    v_add_f32_dpp v24, v24, v24 row_shr:2 row_mask:0xf bank_mask:0xf
    s_nop 1
    v_add_f32_dpp v24, v24, v24 row_shr:4 row_mask:0xf bank_mask:0xf
    s_nop 1
    v_add_f32_dpp v24, v24, v24 row_shr:8 row_mask:0xf bank_mask:0xf
    s_nop 1
    v_add_f32_dpp v24, v24, v24 row_bcast:15 row_mask:0xa bank_mask:0xf
    s_nop 1
    v_add_f32_dpp v24, v24, v24 row_bcast:31 row_mask:0xc bank_mask:0xf
    s_nop 1
    v_readlane_b32 s34, v24, 63
    s_nop 1
    v_mov_b32 v25, s34
    v_mul_f32 v25, 0x3b000000, v25
    v_mov_b32 v24, 0
    v_sub_f32 v26, v16, v25
    v_fma_f32 v24, v26, v26, v24
    v_sub_f32 v26, v17, v25
    v_fma_f32 v24, v26, v26, v24
    v_sub_f32 v26, v18, v25
    v_fma_f32 v24, v26, v26, v24
    v_sub_f32 v26, v19, v25
    v_fma_f32 v24, v26, v26, v24
    v_sub_f32 v26, v20, v25
    v_fma_f32 v24, v26, v26, v24
    v_sub_f32 v26, v21, v25
    v_fma_f32 v24, v26, v26, v24
    v_sub_f32 v26, v22, v25
    v_fma_f32 v24, v26, v26, v24
    v_sub_f32 v26, v23, v25
    v_fma_f32 v24, v26, v26, v24
    s_nop 1
    v_add_f32_dpp v24, v24, v24 row_shr:1 row_mask:0xf bank_mask:0xf
    s_nop 1
    v_add_f32_dpp v24, v24, v24 row_shr:2 row_mask:0xf bank_mask:0xf
    s_nop 1
    v_add_f32_dpp v24, v24, v24 row_shr:4 row_mask:0xf bank_mask:0xf
    s_nop 1
    v_add_f32_dpp v24, v24, v24 row_shr:8 row_mask:0xf bank_mask:0xf
    s_nop 1
    v_add_f32_dpp v24, v24, v24 row_bcast:15 row_mask:0xa bank_mask:0xf
    s_nop 1
    v_add_f32_dpp v24, v24, v24 row_bcast:31 row_mask:0xc bank_mask:0xf
    s_nop 1
    v_readlane_b32 s35, v24, 63
    s_nop 1
    v_mov_b32 v26, s35
    v_mul_f32 v26, 0x3b000000, v26
    v_cvt_pk_bf16_f32 v26, v26, v26
    v_lshlrev_b32 v26, 16, v26
    v_cvt_pk_bf16_f32 v25, v25, v25
    v_lshlrev_b32 v25, 16, v25
    v_add_f32 v26, 0x3727c5ac, v26
    v_cvt_pk_bf16_f32 v26, v26, v26
    v_lshlrev_b32 v26, 16, v26
    v_sqrt_f32 v26, v26
    s_nop 0
    v_cvt_pk_bf16_f32 v26, v26, v26
    v_lshlrev_b32 v26, 16, v26
    v_rcp_f32 v26, v26
    v_sub_f32 v16, v16, v25
    v_cvt_pk_bf16_f32 v16, v16, v16
    v_lshlrev_b32 v16, 16, v16
    v_mul_f32 v16, v16, v26
    v_cvt_pk_bf16_f32 v16, v16, v16
    v_lshlrev_b32 v16, 16, v16
    ds_write_b32 v6, v16 offset:0
    v_sub_f32 v17, v17, v25
    v_cvt_pk_bf16_f32 v17, v17, v17
    v_lshlrev_b32 v17, 16, v17
    v_mul_f32 v17, v17, v26
    v_cvt_pk_bf16_f32 v17, v17, v17
    v_lshlrev_b32 v17, 16, v17
    ds_write_b32 v6, v17 offset:32
    v_sub_f32 v18, v18, v25
    v_cvt_pk_bf16_f32 v18, v18, v18
    v_lshlrev_b32 v18, 16, v18
    v_mul_f32 v18, v18, v26
    v_cvt_pk_bf16_f32 v18, v18, v18
    v_lshlrev_b32 v18, 16, v18
    ds_write_b32 v6, v18 offset:64
    v_sub_f32 v19, v19, v25
    v_cvt_pk_bf16_f32 v19, v19, v19
    v_lshlrev_b32 v19, 16, v19
    v_mul_f32 v19, v19, v26
    v_cvt_pk_bf16_f32 v19, v19, v19
    v_lshlrev_b32 v19, 16, v19
    ds_write_b32 v6, v19 offset:96
    v_sub_f32 v20, v20, v25
    v_cvt_pk_bf16_f32 v20, v20, v20
    v_lshlrev_b32 v20, 16, v20
    v_mul_f32 v20, v20, v26
    v_cvt_pk_bf16_f32 v20, v20, v20
    v_lshlrev_b32 v20, 16, v20
    ds_write_b32 v6, v20 offset:128
    v_sub_f32 v21, v21, v25
    v_cvt_pk_bf16_f32 v21, v21, v21
    v_lshlrev_b32 v21, 16, v21
    v_mul_f32 v21, v21, v26
    v_cvt_pk_bf16_f32 v21, v21, v21
    v_lshlrev_b32 v21, 16, v21
    ds_write_b32 v6, v21 offset:160
    v_sub_f32 v22, v22, v25
    v_cvt_pk_bf16_f32 v22, v22, v22
    v_lshlrev_b32 v22, 16, v22
    v_mul_f32 v22, v22, v26
    v_cvt_pk_bf16_f32 v22, v22, v22
    v_lshlrev_b32 v22, 16, v22
    ds_write_b32 v6, v22 offset:192
    v_sub_f32 v23, v23, v25
    v_cvt_pk_bf16_f32 v23, v23, v23
    v_lshlrev_b32 v23, 16, v23
    v_mul_f32 v23, v23, v26
    v_cvt_pk_bf16_f32 v23, v23, v23
    v_lshlrev_b32 v23, 16, v23
    ds_write_b32 v6, v23 offset:224
    v_lshlrev_b32 v16, 16, v12
    v_and_b32 v17, 0xffff0000, v12
    v_lshlrev_b32 v18, 16, v13
    v_and_b32 v19, 0xffff0000, v13
    v_lshlrev_b32 v20, 16, v14
    v_and_b32 v21, 0xffff0000, v14
    v_lshlrev_b32 v22, 16, v15
    v_and_b32 v23, 0xffff0000, v15
    v_add_f32 v24, v16, v17
    v_add_f32 v24, v24, v18
    v_add_f32 v24, v24, v19
    v_add_f32 v24, v24, v20
    v_add_f32 v24, v24, v21
    v_add_f32 v24, v24, v22
    v_add_f32 v24, v24, v23
    s_nop 1
    v_add_f32_dpp v24, v24, v24 row_shr:1 row_mask:0xf bank_mask:0xf
    s_nop 1
    v_add_f32_dpp v24, v24, v24 row_shr:2 row_mask:0xf bank_mask:0xf
    s_nop 1
    v_add_f32_dpp v24, v24, v24 row_shr:4 row_mask:0xf bank_mask:0xf
    s_nop 1
    v_add_f32_dpp v24, v24, v24 row_shr:8 row_mask:0xf bank_mask:0xf
    s_nop 1
    v_add_f32_dpp v24, v24, v24 row_bcast:15 row_mask:0xa bank_mask:0xf
    s_nop 1
    v_add_f32_dpp v24, v24, v24 row_bcast:31 row_mask:0xc bank_mask:0xf
    s_nop 1
    v_readlane_b32 s34, v24, 63
    s_nop 1
    v_mov_b32 v25, s34
    v_mul_f32 v25, 0x3b000000, v25
    v_mov_b32 v24, 0
    v_sub_f32 v26, v16, v25
    v_fma_f32 v24, v26, v26, v24
    v_sub_f32 v26, v17, v25
    v_fma_f32 v24, v26, v26, v24
    v_sub_f32 v26, v18, v25
    v_fma_f32 v24, v26, v26, v24
    v_sub_f32 v26, v19, v25
    v_fma_f32 v24, v26, v26, v24
    v_sub_f32 v26, v20, v25
    v_fma_f32 v24, v26, v26, v24
    v_sub_f32 v26, v21, v25
    v_fma_f32 v24, v26, v26, v24
    v_sub_f32 v26, v22, v25
    v_fma_f32 v24, v26, v26, v24
    v_sub_f32 v26, v23, v25
    v_fma_f32 v24, v26, v26, v24
    s_nop 1
    v_add_f32_dpp v24, v24, v24 row_shr:1 row_mask:0xf bank_mask:0xf
    s_nop 1
    v_add_f32_dpp v24, v24, v24 row_shr:2 row_mask:0xf bank_mask:0xf
    s_nop 1
    v_add_f32_dpp v24, v24, v24 row_shr:4 row_mask:0xf bank_mask:0xf
    s_nop 1
    v_add_f32_dpp v24, v24, v24 row_shr:8 row_mask:0xf bank_mask:0xf
    s_nop 1
    v_add_f32_dpp v24, v24, v24 row_bcast:15 row_mask:0xa bank_mask:0xf
    s_nop 1
    v_add_f32_dpp v24, v24, v24 row_bcast:31 row_mask:0xc bank_mask:0xf
    s_nop 1
    v_readlane_b32 s35, v24, 63
    s_nop 1
    v_mov_b32 v26, s35
    v_mul_f32 v26, 0x3b000000, v26
    v_cvt_pk_bf16_f32 v26, v26, v26
    v_lshlrev_b32 v26, 16, v26
    v_cvt_pk_bf16_f32 v25, v25, v25
    v_lshlrev_b32 v25, 16, v25
    v_add_f32 v26, 0x3727c5ac, v26
    v_cvt_pk_bf16_f32 v26, v26, v26
    v_lshlrev_b32 v26, 16, v26
    v_sqrt_f32 v26, v26
    s_nop 0
    v_cvt_pk_bf16_f32 v26, v26, v26
    v_lshlrev_b32 v26, 16, v26
    v_rcp_f32 v26, v26
    v_sub_f32 v16, v16, v25
    v_cvt_pk_bf16_f32 v16, v16, v16
    v_lshlrev_b32 v16, 16, v16
    v_mul_f32 v16, v16, v26
    v_cvt_pk_bf16_f32 v16, v16, v16
    v_lshlrev_b32 v16, 16, v16
    ds_write_b32 v6, v16 offset:4
    v_sub_f32 v17, v17, v25
    v_cvt_pk_bf16_f32 v17, v17, v17
    v_lshlrev_b32 v17, 16, v17
    v_mul_f32 v17, v17, v26
    v_cvt_pk_bf16_f32 v17, v17, v17
    v_lshlrev_b32 v17, 16, v17
    ds_write_b32 v6, v17 offset:36
    v_sub_f32 v18, v18, v25
    v_cvt_pk_bf16_f32 v18, v18, v18
    v_lshlrev_b32 v18, 16, v18
    v_mul_f32 v18, v18, v26
    v_cvt_pk_bf16_f32 v18, v18, v18
    v_lshlrev_b32 v18, 16, v18
    ds_write_b32 v6, v18 offset:68
    v_sub_f32 v19, v19, v25
    v_cvt_pk_bf16_f32 v19, v19, v19
    v_lshlrev_b32 v19, 16, v19
    v_mul_f32 v19, v19, v26
    v_cvt_pk_bf16_f32 v19, v19, v19
    v_lshlrev_b32 v19, 16, v19
    ds_write_b32 v6, v19 offset:100
    v_sub_f32 v20, v20, v25
    v_cvt_pk_bf16_f32 v20, v20, v20
    v_lshlrev_b32 v20, 16, v20
    v_mul_f32 v20, v20, v26
    v_cvt_pk_bf16_f32 v20, v20, v20
    v_lshlrev_b32 v20, 16, v20
    ds_write_b32 v6, v20 offset:132
    v_sub_f32 v21, v21, v25
    v_cvt_pk_bf16_f32 v21, v21, v21
    v_lshlrev_b32 v21, 16, v21
    v_mul_f32 v21, v21, v26
    v_cvt_pk_bf16_f32 v21, v21, v21
    v_lshlrev_b32 v21, 16, v21
    ds_write_b32 v6, v21 offset:164
    v_sub_f32 v22, v22, v25
    v_cvt_pk_bf16_f32 v22, v22, v22
    v_lshlrev_b32 v22, 16, v22
    v_mul_f32 v22, v22, v26
    v_cvt_pk_bf16_f32 v22, v22, v22
    v_lshlrev_b32 v22, 16, v22
    ds_write_b32 v6, v22 offset:196
    v_sub_f32 v23, v23, v25
    v_cvt_pk_bf16_f32 v23, v23, v23
    v_lshlrev_b32 v23, 16, v23
    v_mul_f32 v23, v23, v26
    v_cvt_pk_bf16_f32 v23, v23, v23
    v_lshlrev_b32 v23, 16, v23
    ds_write_b32 v6, v23 offset:228
    s_waitcnt lgkmcnt(0)
    s_barrier
    v_mov_b32 v32, 0
    v_mov_b32 v33, 0
    v_mov_b32 v34, 0
    v_mov_b32 v35, 0
    v_mov_b32 v36, 0
    v_mov_b32 v37, 0
    v_mov_b32 v38, 0
    v_mov_b32 v39, 0
    v_mov_b32 v40, 0
    v_mov_b32 v41, 0
    v_mov_b32 v42, 0
    v_mov_b32 v43, 0
    v_mov_b32 v44, 0
    v_mov_b32 v45, 0
    v_mov_b32 v46, 0
    v_mov_b32 v47, 0
    v_lshrrev_b32 v7, 4, v1
    v_lshlrev_b32 v7, 5, v7
    v_mul_u32_u24 v27, 4352, v2
    v_add_u32 v7, v7, v27
    ds_read_b128 v[16:19], v7 offset:0
    ds_read_b128 v[20:23], v7 offset:16
    v_lshlrev_b32 v24, 16, v64
    v_and_b32 v25, 0xffff0000, v64
    s_waitcnt lgkmcnt(0)
    v_fma_f32 v32, v16, v24, v32
    v_fma_f32 v33, v16, v25, v33
    v_fma_f32 v34, v17, v24, v34
    v_fma_f32 v35, v17, v25, v35
    v_fma_f32 v36, v18, v24, v36
    v_fma_f32 v37, v18, v25, v37
    v_fma_f32 v38, v19, v24, v38
    v_fma_f32 v39, v19, v25, v39
    v_fma_f32 v40, v20, v24, v40
    v_fma_f32 v41, v20, v25, v41
    v_fma_f32 v42, v21, v24, v42
    v_fma_f32 v43, v21, v25, v43
    v_fma_f32 v44, v22, v24, v44
    v_fma_f32 v45, v22, v25, v45
    v_fma_f32 v46, v23, v24, v46
    v_fma_f32 v47, v23, v25, v47
    ds_read_b128 v[16:19], v7 offset:128
    ds_read_b128 v[20:23], v7 offset:144
    v_lshlrev_b32 v24, 16, v65
    v_and_b32 v25, 0xffff0000, v65
    s_waitcnt lgkmcnt(0)
    v_fma_f32 v32, v16, v24, v32
    v_fma_f32 v33, v16, v25, v33
    v_fma_f32 v34, v17, v24, v34
    v_fma_f32 v35, v17, v25, v35
    v_fma_f32 v36, v18, v24, v36
    v_fma_f32 v37, v18, v25, v37
    v_fma_f32 v38, v19, v24, v38
    v_fma_f32 v39, v19, v25, v39
    v_fma_f32 v40, v20, v24, v40
    v_fma_f32 v41, v20, v25, v41
    v_fma_f32 v42, v21, v24, v42
    v_fma_f32 v43, v21, v25, v43
    v_fma_f32 v44, v22, v24, v44
    v_fma_f32 v45, v22, v25, v45
    v_fma_f32 v46, v23, v24, v46
    v_fma_f32 v47, v23, v25, v47
    ds_read_b128 v[16:19], v7 offset:272
    ds_read_b128 v[20:23], v7 offset:288
    v_lshlrev_b32 v24, 16, v66
    v_and_b32 v25, 0xffff0000, v66
    s_waitcnt lgkmcnt(0)
    v_fma_f32 v32, v16, v24, v32
    v_fma_f32 v33, v16, v25, v33
    v_fma_f32 v34, v17, v24, v34
    v_fma_f32 v35, v17, v25, v35
    v_fma_f32 v36, v18, v24, v36
    v_fma_f32 v37, v18, v25, v37
    v_fma_f32 v38, v19, v24, v38
    v_fma_f32 v39, v19, v25, v39
    v_fma_f32 v40, v20, v24, v40
    v_fma_f32 v41, v20, v25, v41
    v_fma_f32 v42, v21, v24, v42
    v_fma_f32 v43, v21, v25, v43
    v_fma_f32 v44, v22, v24, v44
    v_fma_f32 v45, v22, v25, v45
    v_fma_f32 v46, v23, v24, v46
    v_fma_f32 v47, v23, v25, v47
    ds_read_b128 v[16:19], v7 offset:400
    ds_read_b128 v[20:23], v7 offset:416
    v_lshlrev_b32 v24, 16, v67
    v_and_b32 v25, 0xffff0000, v67
    s_waitcnt lgkmcnt(0)
    v_fma_f32 v32, v16, v24, v32
    v_fma_f32 v33, v16, v25, v33
    v_fma_f32 v34, v17, v24, v34
    v_fma_f32 v35, v17, v25, v35
    v_fma_f32 v36, v18, v24, v36
    v_fma_f32 v37, v18, v25, v37
    v_fma_f32 v38, v19, v24, v38
    v_fma_f32 v39, v19, v25, v39
    v_fma_f32 v40, v20, v24, v40
    v_fma_f32 v41, v20, v25, v41
    v_fma_f32 v42, v21, v24, v42
    v_fma_f32 v43, v21, v25, v43
    v_fma_f32 v44, v22, v24, v44
    v_fma_f32 v45, v22, v25, v45
    v_fma_f32 v46, v23, v24, v46
    v_fma_f32 v47, v23, v25, v47
    ds_read_b128 v[16:19], v7 offset:544
    ds_read_b128 v[20:23], v7 offset:560
    v_lshlrev_b32 v24, 16, v68
    v_and_b32 v25, 0xffff0000, v68
    s_waitcnt lgkmcnt(0)
    v_fma_f32 v32, v16, v24, v32
    v_fma_f32 v33, v16, v25, v33
    v_fma_f32 v34, v17, v24, v34
    v_fma_f32 v35, v17, v25, v35
    v_fma_f32 v36, v18, v24, v36
    v_fma_f32 v37, v18, v25, v37
    v_fma_f32 v38, v19, v24, v38
    v_fma_f32 v39, v19, v25, v39
    v_fma_f32 v40, v20, v24, v40
    v_fma_f32 v41, v20, v25, v41
    v_fma_f32 v42, v21, v24, v42
    v_fma_f32 v43, v21, v25, v43
    v_fma_f32 v44, v22, v24, v44
    v_fma_f32 v45, v22, v25, v45
    v_fma_f32 v46, v23, v24, v46
    v_fma_f32 v47, v23, v25, v47
    ds_read_b128 v[16:19], v7 offset:672
    ds_read_b128 v[20:23], v7 offset:688
    v_lshlrev_b32 v24, 16, v69
    v_and_b32 v25, 0xffff0000, v69
    s_waitcnt lgkmcnt(0)
    v_fma_f32 v32, v16, v24, v32
    v_fma_f32 v33, v16, v25, v33
    v_fma_f32 v34, v17, v24, v34
    v_fma_f32 v35, v17, v25, v35
    v_fma_f32 v36, v18, v24, v36
    v_fma_f32 v37, v18, v25, v37
    v_fma_f32 v38, v19, v24, v38
    v_fma_f32 v39, v19, v25, v39
    v_fma_f32 v40, v20, v24, v40
    v_fma_f32 v41, v20, v25, v41
    v_fma_f32 v42, v21, v24, v42
    v_fma_f32 v43, v21, v25, v43
    v_fma_f32 v44, v22, v24, v44
    v_fma_f32 v45, v22, v25, v45
    v_fma_f32 v46, v23, v24, v46
    v_fma_f32 v47, v23, v25, v47
    ds_read_b128 v[16:19], v7 offset:816
    ds_read_b128 v[20:23], v7 offset:832
    v_lshlrev_b32 v24, 16, v70
    v_and_b32 v25, 0xffff0000, v70
    s_waitcnt lgkmcnt(0)
    v_fma_f32 v32, v16, v24, v32
    v_fma_f32 v33, v16, v25, v33
    v_fma_f32 v34, v17, v24, v34
    v_fma_f32 v35, v17, v25, v35
    v_fma_f32 v36, v18, v24, v36
    v_fma_f32 v37, v18, v25, v37
    v_fma_f32 v38, v19, v24, v38
    v_fma_f32 v39, v19, v25, v39
    v_fma_f32 v40, v20, v24, v40
    v_fma_f32 v41, v20, v25, v41
    v_fma_f32 v42, v21, v24, v42
    v_fma_f32 v43, v21, v25, v43
    v_fma_f32 v44, v22, v24, v44
    v_fma_f32 v45, v22, v25, v45
    v_fma_f32 v46, v23, v24, v46
    v_fma_f32 v47, v23, v25, v47
    ds_read_b128 v[16:19], v7 offset:944
    ds_read_b128 v[20:23], v7 offset:960
    v_lshlrev_b32 v24, 16, v71
    v_and_b32 v25, 0xffff0000, v71
    s_waitcnt lgkmcnt(0)
    v_fma_f32 v32, v16, v24, v32
    v_fma_f32 v33, v16, v25, v33
    v_fma_f32 v34, v17, v24, v34
    v_fma_f32 v35, v17, v25, v35
    v_fma_f32 v36, v18, v24, v36
    v_fma_f32 v37, v18, v25, v37
    v_fma_f32 v38, v19, v24, v38
    v_fma_f32 v39, v19, v25, v39
    v_fma_f32 v40, v20, v24, v40
    v_fma_f32 v41, v20, v25, v41
    v_fma_f32 v42, v21, v24, v42
    v_fma_f32 v43, v21, v25, v43
    v_fma_f32 v44, v22, v24, v44
    v_fma_f32 v45, v22, v25, v45
    v_fma_f32 v46, v23, v24, v46
    v_fma_f32 v47, v23, v25, v47
    ds_read_b128 v[16:19], v7 offset:1088
    ds_read_b128 v[20:23], v7 offset:1104
    v_lshlrev_b32 v24, 16, v72
    v_and_b32 v25, 0xffff0000, v72
    s_waitcnt lgkmcnt(0)
    v_fma_f32 v32, v16, v24, v32
    v_fma_f32 v33, v16, v25, v33
    v_fma_f32 v34, v17, v24, v34
    v_fma_f32 v35, v17, v25, v35
    v_fma_f32 v36, v18, v24, v36
    v_fma_f32 v37, v18, v25, v37
    v_fma_f32 v38, v19, v24, v38
    v_fma_f32 v39, v19, v25, v39
    v_fma_f32 v40, v20, v24, v40
    v_fma_f32 v41, v20, v25, v41
    v_fma_f32 v42, v21, v24, v42
    v_fma_f32 v43, v21, v25, v43
    v_fma_f32 v44, v22, v24, v44
    v_fma_f32 v45, v22, v25, v45
    v_fma_f32 v46, v23, v24, v46
    v_fma_f32 v47, v23, v25, v47
    ds_read_b128 v[16:19], v7 offset:1216
    ds_read_b128 v[20:23], v7 offset:1232
    v_lshlrev_b32 v24, 16, v73
    v_and_b32 v25, 0xffff0000, v73
    s_waitcnt lgkmcnt(0)
    v_fma_f32 v32, v16, v24, v32
    v_fma_f32 v33, v16, v25, v33
    v_fma_f32 v34, v17, v24, v34
    v_fma_f32 v35, v17, v25, v35
    v_fma_f32 v36, v18, v24, v36
    v_fma_f32 v37, v18, v25, v37
    v_fma_f32 v38, v19, v24, v38
    v_fma_f32 v39, v19, v25, v39
    v_fma_f32 v40, v20, v24, v40
    v_fma_f32 v41, v20, v25, v41
    v_fma_f32 v42, v21, v24, v42
    v_fma_f32 v43, v21, v25, v43
    v_fma_f32 v44, v22, v24, v44
    v_fma_f32 v45, v22, v25, v45
    v_fma_f32 v46, v23, v24, v46
    v_fma_f32 v47, v23, v25, v47
    ds_read_b128 v[16:19], v7 offset:1360
    ds_read_b128 v[20:23], v7 offset:1376
    v_lshlrev_b32 v24, 16, v74
    v_and_b32 v25, 0xffff0000, v74
    s_waitcnt lgkmcnt(0)
    v_fma_f32 v32, v16, v24, v32
    v_fma_f32 v33, v16, v25, v33
    v_fma_f32 v34, v17, v24, v34
    v_fma_f32 v35, v17, v25, v35
    v_fma_f32 v36, v18, v24, v36
    v_fma_f32 v37, v18, v25, v37
    v_fma_f32 v38, v19, v24, v38
    v_fma_f32 v39, v19, v25, v39
    v_fma_f32 v40, v20, v24, v40
    v_fma_f32 v41, v20, v25, v41
    v_fma_f32 v42, v21, v24, v42
    v_fma_f32 v43, v21, v25, v43
    v_fma_f32 v44, v22, v24, v44
    v_fma_f32 v45, v22, v25, v45
    v_fma_f32 v46, v23, v24, v46
    v_fma_f32 v47, v23, v25, v47
    ds_read_b128 v[16:19], v7 offset:1488
    ds_read_b128 v[20:23], v7 offset:1504
    v_lshlrev_b32 v24, 16, v75
    v_and_b32 v25, 0xffff0000, v75
    s_waitcnt lgkmcnt(0)
    v_fma_f32 v32, v16, v24, v32
    v_fma_f32 v33, v16, v25, v33
    v_fma_f32 v34, v17, v24, v34
    v_fma_f32 v35, v17, v25, v35
    v_fma_f32 v36, v18, v24, v36
    v_fma_f32 v37, v18, v25, v37
    v_fma_f32 v38, v19, v24, v38
    v_fma_f32 v39, v19, v25, v39
    v_fma_f32 v40, v20, v24, v40
    v_fma_f32 v41, v20, v25, v41
    v_fma_f32 v42, v21, v24, v42
    v_fma_f32 v43, v21, v25, v43
    v_fma_f32 v44, v22, v24, v44
    v_fma_f32 v45, v22, v25, v45
    v_fma_f32 v46, v23, v24, v46
    v_fma_f32 v47, v23, v25, v47
    ds_read_b128 v[16:19], v7 offset:1632
    ds_read_b128 v[20:23], v7 offset:1648
    v_lshlrev_b32 v24, 16, v76
    v_and_b32 v25, 0xffff0000, v76
    s_waitcnt lgkmcnt(0)
    v_fma_f32 v32, v16, v24, v32
    v_fma_f32 v33, v16, v25, v33
    v_fma_f32 v34, v17, v24, v34
    v_fma_f32 v35, v17, v25, v35
    v_fma_f32 v36, v18, v24, v36
    v_fma_f32 v37, v18, v25, v37
    v_fma_f32 v38, v19, v24, v38
    v_fma_f32 v39, v19, v25, v39
    v_fma_f32 v40, v20, v24, v40
    v_fma_f32 v41, v20, v25, v41
    v_fma_f32 v42, v21, v24, v42
    v_fma_f32 v43, v21, v25, v43
    v_fma_f32 v44, v22, v24, v44
    v_fma_f32 v45, v22, v25, v45
    v_fma_f32 v46, v23, v24, v46
    v_fma_f32 v47, v23, v25, v47
    ds_read_b128 v[16:19], v7 offset:1760
    ds_read_b128 v[20:23], v7 offset:1776
    v_lshlrev_b32 v24, 16, v77
    v_and_b32 v25, 0xffff0000, v77
    s_waitcnt lgkmcnt(0)
    v_fma_f32 v32, v16, v24, v32
    v_fma_f32 v33, v16, v25, v33
    v_fma_f32 v34, v17, v24, v34
    v_fma_f32 v35, v17, v25, v35
    v_fma_f32 v36, v18, v24, v36
    v_fma_f32 v37, v18, v25, v37
    v_fma_f32 v38, v19, v24, v38
    v_fma_f32 v39, v19, v25, v39
    v_fma_f32 v40, v20, v24, v40
    v_fma_f32 v41, v20, v25, v41
    v_fma_f32 v42, v21, v24, v42
    v_fma_f32 v43, v21, v25, v43
    v_fma_f32 v44, v22, v24, v44
    v_fma_f32 v45, v22, v25, v45
    v_fma_f32 v46, v23, v24, v46
    v_fma_f32 v47, v23, v25, v47
    ds_read_b128 v[16:19], v7 offset:1904
    ds_read_b128 v[20:23], v7 offset:1920
    v_lshlrev_b32 v24, 16, v78
    v_and_b32 v25, 0xffff0000, v78
    s_waitcnt lgkmcnt(0)
    v_fma_f32 v32, v16, v24, v32
    v_fma_f32 v33, v16, v25, v33
    v_fma_f32 v34, v17, v24, v34
    v_fma_f32 v35, v17, v25, v35
    v_fma_f32 v36, v18, v24, v36
    v_fma_f32 v37, v18, v25, v37
    v_fma_f32 v38, v19, v24, v38
    v_fma_f32 v39, v19, v25, v39
    v_fma_f32 v40, v20, v24, v40
    v_fma_f32 v41, v20, v25, v41
    v_fma_f32 v42, v21, v24, v42
    v_fma_f32 v43, v21, v25, v43
    v_fma_f32 v44, v22, v24, v44
    v_fma_f32 v45, v22, v25, v45
    v_fma_f32 v46, v23, v24, v46
    v_fma_f32 v47, v23, v25, v47
    ds_read_b128 v[16:19], v7 offset:2032
    ds_read_b128 v[20:23], v7 offset:2048
    v_lshlrev_b32 v24, 16, v79
    v_and_b32 v25, 0xffff0000, v79
    s_waitcnt lgkmcnt(0)
    v_fma_f32 v32, v16, v24, v32
    v_fma_f32 v33, v16, v25, v33
    v_fma_f32 v34, v17, v24, v34
    v_fma_f32 v35, v17, v25, v35
    v_fma_f32 v36, v18, v24, v36
    v_fma_f32 v37, v18, v25, v37
    v_fma_f32 v38, v19, v24, v38
    v_fma_f32 v39, v19, v25, v39
    v_fma_f32 v40, v20, v24, v40
    v_fma_f32 v41, v20, v25, v41
    v_fma_f32 v42, v21, v24, v42
    v_fma_f32 v43, v21, v25, v43
    v_fma_f32 v44, v22, v24, v44
    v_fma_f32 v45, v22, v25, v45
    v_fma_f32 v46, v23, v24, v46
    v_fma_f32 v47, v23, v25, v47
    ds_read_b128 v[16:19], v7 offset:2176
    ds_read_b128 v[20:23], v7 offset:2192
    v_lshlrev_b32 v24, 16, v80
    v_and_b32 v25, 0xffff0000, v80
    s_waitcnt lgkmcnt(0)
    v_fma_f32 v32, v16, v24, v32
    v_fma_f32 v33, v16, v25, v33
    v_fma_f32 v34, v17, v24, v34
    v_fma_f32 v35, v17, v25, v35
    v_fma_f32 v36, v18, v24, v36
    v_fma_f32 v37, v18, v25, v37
    v_fma_f32 v38, v19, v24, v38
    v_fma_f32 v39, v19, v25, v39
    v_fma_f32 v40, v20, v24, v40
    v_fma_f32 v41, v20, v25, v41
    v_fma_f32 v42, v21, v24, v42
    v_fma_f32 v43, v21, v25, v43
    v_fma_f32 v44, v22, v24, v44
    v_fma_f32 v45, v22, v25, v45
    v_fma_f32 v46, v23, v24, v46
    v_fma_f32 v47, v23, v25, v47
    ds_read_b128 v[16:19], v7 offset:2304
    ds_read_b128 v[20:23], v7 offset:2320
    v_lshlrev_b32 v24, 16, v81
    v_and_b32 v25, 0xffff0000, v81
    s_waitcnt lgkmcnt(0)
    v_fma_f32 v32, v16, v24, v32
    v_fma_f32 v33, v16, v25, v33
    v_fma_f32 v34, v17, v24, v34
    v_fma_f32 v35, v17, v25, v35
    v_fma_f32 v36, v18, v24, v36
    v_fma_f32 v37, v18, v25, v37
    v_fma_f32 v38, v19, v24, v38
    v_fma_f32 v39, v19, v25, v39
    v_fma_f32 v40, v20, v24, v40
    v_fma_f32 v41, v20, v25, v41
    v_fma_f32 v42, v21, v24, v42
    v_fma_f32 v43, v21, v25, v43
    v_fma_f32 v44, v22, v24, v44
    v_fma_f32 v45, v22, v25, v45
    v_fma_f32 v46, v23, v24, v46
    v_fma_f32 v47, v23, v25, v47
    ds_read_b128 v[16:19], v7 offset:2448
    ds_read_b128 v[20:23], v7 offset:2464
    v_lshlrev_b32 v24, 16, v82
    v_and_b32 v25, 0xffff0000, v82
    s_waitcnt lgkmcnt(0)
    v_fma_f32 v32, v16, v24, v32
    v_fma_f32 v33, v16, v25, v33
    v_fma_f32 v34, v17, v24, v34
    v_fma_f32 v35, v17, v25, v35
    v_fma_f32 v36, v18, v24, v36
    v_fma_f32 v37, v18, v25, v37
    v_fma_f32 v38, v19, v24, v38
    v_fma_f32 v39, v19, v25, v39
    v_fma_f32 v40, v20, v24, v40
    v_fma_f32 v41, v20, v25, v41
    v_fma_f32 v42, v21, v24, v42
    v_fma_f32 v43, v21, v25, v43
    v_fma_f32 v44, v22, v24, v44
    v_fma_f32 v45, v22, v25, v45
    v_fma_f32 v46, v23, v24, v46
    v_fma_f32 v47, v23, v25, v47
    ds_read_b128 v[16:19], v7 offset:2576
    ds_read_b128 v[20:23], v7 offset:2592
    v_lshlrev_b32 v24, 16, v83
    v_and_b32 v25, 0xffff0000, v83
    s_waitcnt lgkmcnt(0)
    v_fma_f32 v32, v16, v24, v32
    v_fma_f32 v33, v16, v25, v33
    v_fma_f32 v34, v17, v24, v34
    v_fma_f32 v35, v17, v25, v35
    v_fma_f32 v36, v18, v24, v36
    v_fma_f32 v37, v18, v25, v37
    v_fma_f32 v38, v19, v24, v38
    v_fma_f32 v39, v19, v25, v39
    v_fma_f32 v40, v20, v24, v40
    v_fma_f32 v41, v20, v25, v41
    v_fma_f32 v42, v21, v24, v42
    v_fma_f32 v43, v21, v25, v43
    v_fma_f32 v44, v22, v24, v44
    v_fma_f32 v45, v22, v25, v45
    v_fma_f32 v46, v23, v24, v46
    v_fma_f32 v47, v23, v25, v47
    ds_read_b128 v[16:19], v7 offset:2720
    ds_read_b128 v[20:23], v7 offset:2736
    v_lshlrev_b32 v24, 16, v84
    v_and_b32 v25, 0xffff0000, v84
    s_waitcnt lgkmcnt(0)
    v_fma_f32 v32, v16, v24, v32
    v_fma_f32 v33, v16, v25, v33
    v_fma_f32 v34, v17, v24, v34
    v_fma_f32 v35, v17, v25, v35
    v_fma_f32 v36, v18, v24, v36
    v_fma_f32 v37, v18, v25, v37
    v_fma_f32 v38, v19, v24, v38
    v_fma_f32 v39, v19, v25, v39
    v_fma_f32 v40, v20, v24, v40
    v_fma_f32 v41, v20, v25, v41
    v_fma_f32 v42, v21, v24, v42
    v_fma_f32 v43, v21, v25, v43
    v_fma_f32 v44, v22, v24, v44
    v_fma_f32 v45, v22, v25, v45
    v_fma_f32 v46, v23, v24, v46
    v_fma_f32 v47, v23, v25, v47
    ds_read_b128 v[16:19], v7 offset:2848
    ds_read_b128 v[20:23], v7 offset:2864
    v_lshlrev_b32 v24, 16, v85
    v_and_b32 v25, 0xffff0000, v85
    s_waitcnt lgkmcnt(0)
    v_fma_f32 v32, v16, v24, v32
    v_fma_f32 v33, v16, v25, v33
    v_fma_f32 v34, v17, v24, v34
    v_fma_f32 v35, v17, v25, v35
    v_fma_f32 v36, v18, v24, v36
    v_fma_f32 v37, v18, v25, v37
    v_fma_f32 v38, v19, v24, v38
    v_fma_f32 v39, v19, v25, v39
    v_fma_f32 v40, v20, v24, v40
    v_fma_f32 v41, v20, v25, v41
    v_fma_f32 v42, v21, v24, v42
    v_fma_f32 v43, v21, v25, v43
    v_fma_f32 v44, v22, v24, v44
    v_fma_f32 v45, v22, v25, v45
    v_fma_f32 v46, v23, v24, v46
    v_fma_f32 v47, v23, v25, v47
    ds_read_b128 v[16:19], v7 offset:2992
    ds_read_b128 v[20:23], v7 offset:3008
    v_lshlrev_b32 v24, 16, v86
    v_and_b32 v25, 0xffff0000, v86
    s_waitcnt lgkmcnt(0)
    v_fma_f32 v32, v16, v24, v32
    v_fma_f32 v33, v16, v25, v33
    v_fma_f32 v34, v17, v24, v34
    v_fma_f32 v35, v17, v25, v35
    v_fma_f32 v36, v18, v24, v36
    v_fma_f32 v37, v18, v25, v37
    v_fma_f32 v38, v19, v24, v38
    v_fma_f32 v39, v19, v25, v39
    v_fma_f32 v40, v20, v24, v40
    v_fma_f32 v41, v20, v25, v41
    v_fma_f32 v42, v21, v24, v42
    v_fma_f32 v43, v21, v25, v43
    v_fma_f32 v44, v22, v24, v44
    v_fma_f32 v45, v22, v25, v45
    v_fma_f32 v46, v23, v24, v46
    v_fma_f32 v47, v23, v25, v47
    ds_read_b128 v[16:19], v7 offset:3120
    ds_read_b128 v[20:23], v7 offset:3136
    v_lshlrev_b32 v24, 16, v87
    v_and_b32 v25, 0xffff0000, v87
    s_waitcnt lgkmcnt(0)
    v_fma_f32 v32, v16, v24, v32
    v_fma_f32 v33, v16, v25, v33
    v_fma_f32 v34, v17, v24, v34
    v_fma_f32 v35, v17, v25, v35
    v_fma_f32 v36, v18, v24, v36
    v_fma_f32 v37, v18, v25, v37
    v_fma_f32 v38, v19, v24, v38
    v_fma_f32 v39, v19, v25, v39
    v_fma_f32 v40, v20, v24, v40
    v_fma_f32 v41, v20, v25, v41
    v_fma_f32 v42, v21, v24, v42
    v_fma_f32 v43, v21, v25, v43
    v_fma_f32 v44, v22, v24, v44
    v_fma_f32 v45, v22, v25, v45
    v_fma_f32 v46, v23, v24, v46
    v_fma_f32 v47, v23, v25, v47
    ds_read_b128 v[16:19], v7 offset:3264
    ds_read_b128 v[20:23], v7 offset:3280
    v_lshlrev_b32 v24, 16, v88
    v_and_b32 v25, 0xffff0000, v88
    s_waitcnt lgkmcnt(0)
    v_fma_f32 v32, v16, v24, v32
    v_fma_f32 v33, v16, v25, v33
    v_fma_f32 v34, v17, v24, v34
    v_fma_f32 v35, v17, v25, v35
    v_fma_f32 v36, v18, v24, v36
    v_fma_f32 v37, v18, v25, v37
    v_fma_f32 v38, v19, v24, v38
    v_fma_f32 v39, v19, v25, v39
    v_fma_f32 v40, v20, v24, v40
    v_fma_f32 v41, v20, v25, v41
    v_fma_f32 v42, v21, v24, v42
    v_fma_f32 v43, v21, v25, v43
    v_fma_f32 v44, v22, v24, v44
    v_fma_f32 v45, v22, v25, v45
    v_fma_f32 v46, v23, v24, v46
    v_fma_f32 v47, v23, v25, v47
    ds_read_b128 v[16:19], v7 offset:3392
    ds_read_b128 v[20:23], v7 offset:3408
    v_lshlrev_b32 v24, 16, v89
    v_and_b32 v25, 0xffff0000, v89
    s_waitcnt lgkmcnt(0)
    v_fma_f32 v32, v16, v24, v32
    v_fma_f32 v33, v16, v25, v33
    v_fma_f32 v34, v17, v24, v34
    v_fma_f32 v35, v17, v25, v35
    v_fma_f32 v36, v18, v24, v36
    v_fma_f32 v37, v18, v25, v37
    v_fma_f32 v38, v19, v24, v38
    v_fma_f32 v39, v19, v25, v39
    v_fma_f32 v40, v20, v24, v40
    v_fma_f32 v41, v20, v25, v41
    v_fma_f32 v42, v21, v24, v42
    v_fma_f32 v43, v21, v25, v43
    v_fma_f32 v44, v22, v24, v44
    v_fma_f32 v45, v22, v25, v45
    v_fma_f32 v46, v23, v24, v46
    v_fma_f32 v47, v23, v25, v47
    ds_read_b128 v[16:19], v7 offset:3536
    ds_read_b128 v[20:23], v7 offset:3552
    v_lshlrev_b32 v24, 16, v90
    v_and_b32 v25, 0xffff0000, v90
    s_waitcnt lgkmcnt(0)
    v_fma_f32 v32, v16, v24, v32
    v_fma_f32 v33, v16, v25, v33
    v_fma_f32 v34, v17, v24, v34
    v_fma_f32 v35, v17, v25, v35
    v_fma_f32 v36, v18, v24, v36
    v_fma_f32 v37, v18, v25, v37
    v_fma_f32 v38, v19, v24, v38
    v_fma_f32 v39, v19, v25, v39
    v_fma_f32 v40, v20, v24, v40
    v_fma_f32 v41, v20, v25, v41
    v_fma_f32 v42, v21, v24, v42
    v_fma_f32 v43, v21, v25, v43
    v_fma_f32 v44, v22, v24, v44
    v_fma_f32 v45, v22, v25, v45
    v_fma_f32 v46, v23, v24, v46
    v_fma_f32 v47, v23, v25, v47
    ds_read_b128 v[16:19], v7 offset:3664
    ds_read_b128 v[20:23], v7 offset:3680
    v_lshlrev_b32 v24, 16, v91
    v_and_b32 v25, 0xffff0000, v91
    s_waitcnt lgkmcnt(0)
    v_fma_f32 v32, v16, v24, v32
    v_fma_f32 v33, v16, v25, v33
    v_fma_f32 v34, v17, v24, v34
    v_fma_f32 v35, v17, v25, v35
    v_fma_f32 v36, v18, v24, v36
    v_fma_f32 v37, v18, v25, v37
    v_fma_f32 v38, v19, v24, v38
    v_fma_f32 v39, v19, v25, v39
    v_fma_f32 v40, v20, v24, v40
    v_fma_f32 v41, v20, v25, v41
    v_fma_f32 v42, v21, v24, v42
    v_fma_f32 v43, v21, v25, v43
    v_fma_f32 v44, v22, v24, v44
    v_fma_f32 v45, v22, v25, v45
    v_fma_f32 v46, v23, v24, v46
    v_fma_f32 v47, v23, v25, v47
    ds_read_b128 v[16:19], v7 offset:3808
    ds_read_b128 v[20:23], v7 offset:3824
    v_lshlrev_b32 v24, 16, v92
    v_and_b32 v25, 0xffff0000, v92
    s_waitcnt lgkmcnt(0)
    v_fma_f32 v32, v16, v24, v32
    v_fma_f32 v33, v16, v25, v33
    v_fma_f32 v34, v17, v24, v34
    v_fma_f32 v35, v17, v25, v35
    v_fma_f32 v36, v18, v24, v36
    v_fma_f32 v37, v18, v25, v37
    v_fma_f32 v38, v19, v24, v38
    v_fma_f32 v39, v19, v25, v39
    v_fma_f32 v40, v20, v24, v40
    v_fma_f32 v41, v20, v25, v41
    v_fma_f32 v42, v21, v24, v42
    v_fma_f32 v43, v21, v25, v43
    v_fma_f32 v44, v22, v24, v44
    v_fma_f32 v45, v22, v25, v45
    v_fma_f32 v46, v23, v24, v46
    v_fma_f32 v47, v23, v25, v47
    ds_read_b128 v[16:19], v7 offset:3936
    ds_read_b128 v[20:23], v7 offset:3952
    v_lshlrev_b32 v24, 16, v93
    v_and_b32 v25, 0xffff0000, v93
    s_waitcnt lgkmcnt(0)
    v_fma_f32 v32, v16, v24, v32
    v_fma_f32 v33, v16, v25, v33
    v_fma_f32 v34, v17, v24, v34
    v_fma_f32 v35, v17, v25, v35
    v_fma_f32 v36, v18, v24, v36
    v_fma_f32 v37, v18, v25, v37
    v_fma_f32 v38, v19, v24, v38
    v_fma_f32 v39, v19, v25, v39
    v_fma_f32 v40, v20, v24, v40
    v_fma_f32 v41, v20, v25, v41
    v_fma_f32 v42, v21, v24, v42
    v_fma_f32 v43, v21, v25, v43
    v_fma_f32 v44, v22, v24, v44
    v_fma_f32 v45, v22, v25, v45
    v_fma_f32 v46, v23, v24, v46
    v_fma_f32 v47, v23, v25, v47
    ds_read_b128 v[16:19], v7 offset:4080
    ds_read_b128 v[20:23], v7 offset:4096
    v_lshlrev_b32 v24, 16, v94
    v_and_b32 v25, 0xffff0000, v94
    s_waitcnt lgkmcnt(0)
    v_fma_f32 v32, v16, v24, v32
    v_fma_f32 v33, v16, v25, v33
    v_fma_f32 v34, v17, v24, v34
    v_fma_f32 v35, v17, v25, v35
    v_fma_f32 v36, v18, v24, v36
    v_fma_f32 v37, v18, v25, v37
    v_fma_f32 v38, v19, v24, v38
    v_fma_f32 v39, v19, v25, v39
    v_fma_f32 v40, v20, v24, v40
    v_fma_f32 v41, v20, v25, v41
    v_fma_f32 v42, v21, v24, v42
    v_fma_f32 v43, v21, v25, v43
    v_fma_f32 v44, v22, v24, v44
    v_fma_f32 v45, v22, v25, v45
    v_fma_f32 v46, v23, v24, v46
    v_fma_f32 v47, v23, v25, v47
    ds_read_b128 v[16:19], v7 offset:4208
    ds_read_b128 v[20:23], v7 offset:4224
    v_lshlrev_b32 v24, 16, v95
    v_and_b32 v25, 0xffff0000, v95
    s_waitcnt lgkmcnt(0)
    v_fma_f32 v32, v16, v24, v32
    v_fma_f32 v33, v16, v25, v33
    v_fma_f32 v34, v17, v24, v34
    v_fma_f32 v35, v17, v25, v35
    v_fma_f32 v36, v18, v24, v36
    v_fma_f32 v37, v18, v25, v37
    v_fma_f32 v38, v19, v24, v38
    v_fma_f32 v39, v19, v25, v39
    v_fma_f32 v40, v20, v24, v40
    v_fma_f32 v41, v20, v25, v41
    v_fma_f32 v42, v21, v24, v42
    v_fma_f32 v43, v21, v25, v43
    v_fma_f32 v44, v22, v24, v44
    v_fma_f32 v45, v22, v25, v45
    v_fma_f32 v46, v23, v24, v46
    v_fma_f32 v47, v23, v25, v47
    s_barrier
    v_lshrrev_b32 v7, 4, v1
    v_lshl_add_u32 v7, v2, 2, v7
    v_lshlrev_b32 v7, 10, v7
    v_lshl_add_u32 v7, v4, 3, v7
    ds_write_b64 v7, v[32:33] offset:0
    ds_write_b64 v7, v[34:35] offset:128
    ds_write_b64 v7, v[36:37] offset:256
    ds_write_b64 v7, v[38:39] offset:384
    ds_write_b64 v7, v[40:41] offset:512
    ds_write_b64 v7, v[42:43] offset:640
    ds_write_b64 v7, v[44:45] offset:768
    ds_write_b64 v7, v[46:47] offset:896
    s_waitcnt lgkmcnt(0)
    s_barrier
    v_lshlrev_b32 v7, 2, v0
    ds_read_b32 v16, v7 offset:0
    ds_read_b32 v17, v7 offset:1024
    ds_read_b32 v18, v7 offset:2048
    ds_read_b32 v19, v7 offset:3072
    ds_read_b32 v20, v7 offset:4096
    ds_read_b32 v21, v7 offset:5120
    ds_read_b32 v22, v7 offset:6144
    ds_read_b32 v23, v7 offset:7168
    ds_read_b32 v24, v7 offset:8192
    ds_read_b32 v25, v7 offset:9216
    ds_read_b32 v26, v7 offset:10240
    ds_read_b32 v27, v7 offset:11264
    ds_read_b32 v28, v7 offset:12288
    ds_read_b32 v29, v7 offset:13312
    ds_read_b32 v30, v7 offset:14336
    ds_read_b32 v31, v7 offset:15360
    s_waitcnt lgkmcnt(0)
    v_add_f32 v16, v16, v17
    v_add_f32 v16, v16, v18
    v_add_f32 v16, v16, v19
    v_add_f32 v16, v16, v20
    v_add_f32 v16, v16, v21
    v_add_f32 v16, v16, v22
    v_add_f32 v16, v16, v23
    v_add_f32 v16, v16, v24
    v_add_f32 v16, v16, v25
    v_add_f32 v16, v16, v26
    v_add_f32 v16, v16, v27
    v_add_f32 v16, v16, v28
    v_add_f32 v16, v16, v29
    v_add_f32 v16, v16, v30
    v_add_f32 v16, v16, v31
    v_and_b32 v8, 31, v0
    v_lshrrev_b32 v9, 5, v0
    s_cmp_ge_u32 s2, 128
    s_cbranch_scc1 K1_FFN
    v_cvt_pk_bf16_f32 v16, v16, v16
    v_lshlrev_b32 v9, 13, v9
    v_lshl_add_u32 v9, v8, 1, v9
    v_add_u32 v9, s31, v9
    buffer_store_short v16, v9, s[16:19], 0 offen
    s_endpgm
K1_FFN:
    v_lshlrev_b32 v10, 1, v8
    v_add_u32 v10, s31, v10
    buffer_load_ushort v11, v10, s[20:23], 0 offen
    v_cvt_pk_bf16_f32 v16, v16, v16
    v_lshlrev_b32 v16, 16, v16
    s_waitcnt vmcnt(0)
    v_lshlrev_b32 v11, 16, v11
    v_add_f32 v16, v16, v11
    v_cvt_pk_bf16_f32 v16, v16, v16
    v_lshlrev_b32 v16, 16, v16
    v_mul_f32 v17, v16, v16
    v_mul_f32 v17, v17, v16
    v_mov_b32 v18, 0x3d372713
    v_fma_f32 v17, v17, v18, v16
    v_mul_f32 v17, 0x40135761, v17
    v_exp_f32 v17, v17
    s_nop 0
    v_add_f32 v17, 1.0, v17
    v_rcp_f32 v17, v17
    s_nop 0
    v_mul_f32 v17, -2.0, v17
    v_add_f32 v17, 2.0, v17
    v_mul_f32 v16, 0.5, v16
    v_mul_f32 v16, v16, v17
    v_cvt_pk_bf16_f32 v16, v16, v16
    v_lshlrev_b32 v16, 16, v16
    v_mul_u32_u24 v9, 7168, v9
    v_lshl_add_u32 v9, v8, 2, v9
    s_lshl_b32 s31, s31, 1
    v_add_u32 v9, s31, v9
    s_mov_b32 s33, 65536
    buffer_store_dword v16, v9, s[16:19], s33 offen
K1_END:
    s_endpgm
.globl k2_kernel
.p2align 8
.type k2_kernel,@function
k2_kernel:
    s_cmp_ge_u32 s2, 512
    s_cbranch_scc1 K2_END
    s_load_dwordx4 s[4:7], s[0:1], 8
    s_load_dwordx2 s[28:29], s[0:1], 96
    v_and_b32 v1, 63, v0
    v_lshrrev_b32 v2, 6, v0
    v_and_b32 v3, 15, v1
    v_lshrrev_b32 v4, 4, v1
    s_lshr_b32 s20, s2, 3
    s_and_b32 s21, s2, 7
    s_lshl_b32 s22, s20, 12
    s_mul_i32 s23, s21, 128
    s_add_u32 s22, s22, s23
    s_add_u32 s22, s22, 3072
    s_lshl_b32 s22, s22, 8
    s_waitcnt lgkmcnt(0)
    s_mov_b32 s8, s4
    s_mov_b32 s9, s5
    s_mov_b32 s10, 134217728
    s_mov_b32 s11, 0x00020000
    s_mov_b32 s12, s6
    s_mov_b32 s13, s7
    s_mov_b32 s14, 134217728
    s_mov_b32 s15, 0x00020000
    s_mov_b32 s16, s28
    s_mov_b32 s17, s29
    s_mov_b32 s18, 268435456
    s_mov_b32 s19, 0x00020000
    v_lshl_add_u32 v5, v2, 5, v3
    v_lshlrev_b32 v5, 8, v5
    v_lshl_add_u32 v5, v4, 6, v5
    s_add_u32 s23, s22, 4096
    buffer_load_dwordx4 v[16:19], v5, s[8:11], s22 offen offset:0
    buffer_load_dwordx4 v[20:23], v5, s[8:11], s22 offen offset:16
    buffer_load_dwordx4 v[24:27], v5, s[8:11], s22 offen offset:32
    buffer_load_dwordx4 v[28:31], v5, s[8:11], s22 offen offset:48
    buffer_load_dwordx4 v[32:35], v5, s[8:11], s23 offen offset:0
    buffer_load_dwordx4 v[36:39], v5, s[8:11], s23 offen offset:16
    buffer_load_dwordx4 v[40:43], v5, s[8:11], s23 offen offset:32
    buffer_load_dwordx4 v[44:47], v5, s[8:11], s23 offen offset:48
    s_lshl_b32 s24, s20, 10
    v_lshlrev_b32 v6, 8, v3
    v_lshl_add_u32 v6, v4, 6, v6
    v_cmp_gt_u32 vcc, 4, v3
    v_mov_b32 v7, 0x7ffffff0
    s_nop 1
    v_cndmask_b32 v6, v7, v6, vcc
    buffer_load_dwordx4 v[80:83], v6, s[16:19], s24 offen offset:0
    buffer_load_dwordx4 v[84:87], v6, s[16:19], s24 offen offset:16
    buffer_load_dwordx4 v[88:91], v6, s[16:19], s24 offen offset:32
    buffer_load_dwordx4 v[92:95], v6, s[16:19], s24 offen offset:48
    v_lshl_add_u32 v7, v2, 5, v4
    v_lshlrev_b32 v7, 8, v7
    v_lshl_add_u32 v7, v3, 4, v7
    buffer_load_dwordx4 v[48:51], v7, s[12:15], s22 offen offset:0
    buffer_load_dwordx4 v[52:55], v7, s[12:15], s22 offen offset:1024
    buffer_load_dwordx4 v[56:59], v7, s[12:15], s22 offen offset:2048
    buffer_load_dwordx4 v[60:63], v7, s[12:15], s22 offen offset:3072
    buffer_load_dwordx4 v[64:67], v7, s[12:15], s23 offen offset:0
    buffer_load_dwordx4 v[68:71], v7, s[12:15], s23 offen offset:1024
    buffer_load_dwordx4 v[72:75], v7, s[12:15], s23 offen offset:2048
    buffer_load_dwordx4 v[76:79], v7, s[12:15], s23 offen offset:3072
    v_mov_b32 v96, 0
    v_mov_b32 v97, 0
    v_mov_b32 v98, 0
    v_mov_b32 v99, 0
    v_mov_b32 v100, 0
    v_mov_b32 v101, 0
    v_mov_b32 v102, 0
    v_mov_b32 v103, 0
    s_waitcnt vmcnt(8)
    v_mfma_f32_16x16x32_bf16 v[96:99], v[80:83], v[16:19], v[96:99]
    v_mfma_f32_16x16x32_bf16 v[96:99], v[84:87], v[20:23], v[96:99]
    v_mfma_f32_16x16x32_bf16 v[96:99], v[88:91], v[24:27], v[96:99]
    v_mfma_f32_16x16x32_bf16 v[96:99], v[92:95], v[28:31], v[96:99]
    v_mfma_f32_16x16x32_bf16 v[100:103], v[80:83], v[32:35], v[100:103]
    v_mfma_f32_16x16x32_bf16 v[100:103], v[84:87], v[36:39], v[100:103]
    v_mfma_f32_16x16x32_bf16 v[100:103], v[88:91], v[40:43], v[100:103]
    v_mfma_f32_16x16x32_bf16 v[100:103], v[92:95], v[44:47], v[100:103]
    s_nop 7
    s_nop 1
    v_cvt_pk_bf16_f32 v96, v96, v96
    v_lshlrev_b32 v96, 16, v96
    v_mul_f32 v96, 0x3db504f3, v96
    v_cvt_pk_bf16_f32 v96, v96, v96
    v_lshlrev_b32 v96, 16, v96
    v_cvt_pk_bf16_f32 v97, v97, v97
    v_lshlrev_b32 v97, 16, v97
    v_mul_f32 v97, 0x3db504f3, v97
    v_cvt_pk_bf16_f32 v97, v97, v97
    v_lshlrev_b32 v97, 16, v97
    v_cvt_pk_bf16_f32 v98, v98, v98
    v_lshlrev_b32 v98, 16, v98
    v_mul_f32 v98, 0x3db504f3, v98
    v_cvt_pk_bf16_f32 v98, v98, v98
    v_lshlrev_b32 v98, 16, v98
    v_cvt_pk_bf16_f32 v99, v99, v99
    v_lshlrev_b32 v99, 16, v99
    v_mul_f32 v99, 0x3db504f3, v99
    v_cvt_pk_bf16_f32 v99, v99, v99
    v_lshlrev_b32 v99, 16, v99
    v_cvt_pk_bf16_f32 v100, v100, v100
    v_lshlrev_b32 v100, 16, v100
    v_mul_f32 v100, 0x3db504f3, v100
    v_cvt_pk_bf16_f32 v100, v100, v100
    v_lshlrev_b32 v100, 16, v100
    v_cvt_pk_bf16_f32 v101, v101, v101
    v_lshlrev_b32 v101, 16, v101
    v_mul_f32 v101, 0x3db504f3, v101
    v_cvt_pk_bf16_f32 v101, v101, v101
    v_lshlrev_b32 v101, 16, v101
    v_cvt_pk_bf16_f32 v102, v102, v102
    v_lshlrev_b32 v102, 16, v102
    v_mul_f32 v102, 0x3db504f3, v102
    v_cvt_pk_bf16_f32 v102, v102, v102
    v_lshlrev_b32 v102, 16, v102
    v_cvt_pk_bf16_f32 v103, v103, v103
    v_lshlrev_b32 v103, 16, v103
    v_mul_f32 v103, 0x3db504f3, v103
    v_cvt_pk_bf16_f32 v103, v103, v103
    v_lshlrev_b32 v103, 16, v103
    v_lshl_add_u32 v5, v2, 5, v1
    v_lshlrev_b32 v5, 2, v5
    v_cmp_gt_u32 vcc, 16, v1
    s_and_saveexec_b64 s[26:27], vcc
    ds_write_b32 v5, v96 offset:0
    ds_write_b32 v5, v97 offset:512
    ds_write_b32 v5, v98 offset:1024
    ds_write_b32 v5, v99 offset:1536
    ds_write_b32 v5, v100 offset:64
    ds_write_b32 v5, v101 offset:576
    ds_write_b32 v5, v102 offset:1088
    ds_write_b32 v5, v103 offset:1600
    s_mov_b64 exec, s[26:27]
    s_waitcnt lgkmcnt(0)
    s_barrier
    v_lshlrev_b32 v5, 9, v2
    v_lshl_add_u32 v5, v1, 3, v5
    ds_read_b64 v[8:9], v5
    s_waitcnt lgkmcnt(0)
    v_max_f32 v10, v8, v9
    s_nop 1
    v_max_f32_dpp v10, v10, v10 row_shr:1 row_mask:0xf bank_mask:0xf
    s_nop 1
    v_max_f32_dpp v10, v10, v10 row_shr:2 row_mask:0xf bank_mask:0xf
    s_nop 1
    v_max_f32_dpp v10, v10, v10 row_shr:4 row_mask:0xf bank_mask:0xf
    s_nop 1
    v_max_f32_dpp v10, v10, v10 row_shr:8 row_mask:0xf bank_mask:0xf
    s_nop 1
    v_max_f32_dpp v10, v10, v10 row_bcast:15 row_mask:0xa bank_mask:0xf
    s_nop 1
    v_max_f32_dpp v10, v10, v10 row_bcast:31 row_mask:0xc bank_mask:0xf
    s_nop 1
    v_readlane_b32 s30, v10, 63
    s_nop 1
    v_subrev_f32 v8, s30, v8
    v_subrev_f32 v9, s30, v9
    v_mul_f32 v8, 0x3fb8aa3b, v8
    v_mul_f32 v9, 0x3fb8aa3b, v9
    v_exp_f32 v8, v8
    v_exp_f32 v9, v9
    s_nop 0
    v_add_f32 v10, v8, v9
    s_nop 1
    v_add_f32_dpp v10, v10, v10 row_shr:1 row_mask:0xf bank_mask:0xf
    s_nop 1
    v_add_f32_dpp v10, v10, v10 row_shr:2 row_mask:0xf bank_mask:0xf
    s_nop 1
    v_add_f32_dpp v10, v10, v10 row_shr:4 row_mask:0xf bank_mask:0xf
    s_nop 1
    v_add_f32_dpp v10, v10, v10 row_shr:8 row_mask:0xf bank_mask:0xf
    s_nop 1
    v_add_f32_dpp v10, v10, v10 row_bcast:15 row_mask:0xa bank_mask:0xf
    s_nop 1
    v_add_f32_dpp v10, v10, v10 row_bcast:31 row_mask:0xc bank_mask:0xf
    s_nop 1
    v_readlane_b32 s31, v10, 63
    v_lshlrev_b32 v5, 5, v1
    v_lshl_add_u32 v5, v2, 2, v5
    ds_write_b32 v5, v8 offset:2048
    ds_write_b32 v5, v9 offset:2064
    v_mov_b32 v10, s30
    v_mov_b32 v11, s31
    s_lshl_b32 s25, s2, 5
    s_add_u32 s25, s25, 131072
    v_lshlrev_b32 v12, 3, v2
    v_cmp_eq_u32 vcc, 0, v1
    s_and_saveexec_b64 s[26:27], vcc
    buffer_store_dwordx2 v[10:11], v12, s[16:19], s25 offen
    s_mov_b64 exec, s[26:27]
    s_waitcnt lgkmcnt(0)
    s_barrier
    v_mov_b32 v16, 0
    v_mov_b32 v17, 0
    v_mov_b32 v18, 0
    v_mov_b32 v19, 0
    v_mov_b32 v20, 0
    v_mov_b32 v21, 0
    v_mov_b32 v22, 0
    v_mov_b32 v23, 0
    v_mov_b32 v24, 0
    v_mov_b32 v25, 0
    v_mov_b32 v26, 0
    v_mov_b32 v27, 0
    v_mov_b32 v28, 0
    v_mov_b32 v29, 0
    v_mov_b32 v30, 0
    v_mov_b32 v31, 0
    v_mov_b32 v32, 0
    v_mov_b32 v33, 0
    v_mov_b32 v34, 0
    v_mov_b32 v35, 0
    v_mov_b32 v36, 0
    v_mov_b32 v37, 0
    v_mov_b32 v38, 0
    v_mov_b32 v39, 0
    v_mov_b32 v40, 0
    v_mov_b32 v41, 0
    v_mov_b32 v42, 0
    v_mov_b32 v43, 0
    v_mov_b32 v44, 0
    v_mov_b32 v45, 0
    v_mov_b32 v46, 0
    v_mov_b32 v47, 0
    v_lshl_add_u32 v5, v2, 5, v4
    v_lshlrev_b32 v5, 4, v5
    s_waitcnt vmcnt(1)
    ds_read_b128 v[8:11], v5 offset:2048
    v_lshlrev_b32 v80, 16, v48
    v_and_b32 v81, 0xffff0000, v48
    v_lshlrev_b32 v82, 16, v49
    v_and_b32 v83, 0xffff0000, v49
    v_lshlrev_b32 v84, 16, v50
    v_and_b32 v85, 0xffff0000, v50
    v_lshlrev_b32 v86, 16, v51
    v_and_b32 v87, 0xffff0000, v51
    s_waitcnt lgkmcnt(0)
    v_fma_f32 v16, v8, v80, v16
    v_fma_f32 v17, v8, v81, v17
    v_fma_f32 v18, v8, v82, v18
    v_fma_f32 v19, v8, v83, v19
    v_fma_f32 v20, v8, v84, v20
    v_fma_f32 v21, v8, v85, v21
    v_fma_f32 v22, v8, v86, v22
    v_fma_f32 v23, v8, v87, v23
    v_fma_f32 v24, v9, v80, v24
    v_fma_f32 v25, v9, v81, v25
    v_fma_f32 v26, v9, v82, v26
    v_fma_f32 v27, v9, v83, v27
    v_fma_f32 v28, v9, v84, v28
    v_fma_f32 v29, v9, v85, v29
    v_fma_f32 v30, v9, v86, v30
    v_fma_f32 v31, v9, v87, v31
    v_fma_f32 v32, v10, v80, v32
    v_fma_f32 v33, v10, v81, v33
    v_fma_f32 v34, v10, v82, v34
    v_fma_f32 v35, v10, v83, v35
    v_fma_f32 v36, v10, v84, v36
    v_fma_f32 v37, v10, v85, v37
    v_fma_f32 v38, v10, v86, v38
    v_fma_f32 v39, v10, v87, v39
    v_fma_f32 v40, v11, v80, v40
    v_fma_f32 v41, v11, v81, v41
    v_fma_f32 v42, v11, v82, v42
    v_fma_f32 v43, v11, v83, v43
    v_fma_f32 v44, v11, v84, v44
    v_fma_f32 v45, v11, v85, v45
    v_fma_f32 v46, v11, v86, v46
    v_fma_f32 v47, v11, v87, v47
    ds_read_b128 v[8:11], v5 offset:2112
    v_lshlrev_b32 v80, 16, v52
    v_and_b32 v81, 0xffff0000, v52
    v_lshlrev_b32 v82, 16, v53
    v_and_b32 v83, 0xffff0000, v53
    v_lshlrev_b32 v84, 16, v54
    v_and_b32 v85, 0xffff0000, v54
    v_lshlrev_b32 v86, 16, v55
    v_and_b32 v87, 0xffff0000, v55
    s_waitcnt lgkmcnt(0)
    v_fma_f32 v16, v8, v80, v16
    v_fma_f32 v17, v8, v81, v17
    v_fma_f32 v18, v8, v82, v18
    v_fma_f32 v19, v8, v83, v19
    v_fma_f32 v20, v8, v84, v20
    v_fma_f32 v21, v8, v85, v21
    v_fma_f32 v22, v8, v86, v22
    v_fma_f32 v23, v8, v87, v23
    v_fma_f32 v24, v9, v80, v24
    v_fma_f32 v25, v9, v81, v25
    v_fma_f32 v26, v9, v82, v26
    v_fma_f32 v27, v9, v83, v27
    v_fma_f32 v28, v9, v84, v28
    v_fma_f32 v29, v9, v85, v29
    v_fma_f32 v30, v9, v86, v30
    v_fma_f32 v31, v9, v87, v31
    v_fma_f32 v32, v10, v80, v32
    v_fma_f32 v33, v10, v81, v33
    v_fma_f32 v34, v10, v82, v34
    v_fma_f32 v35, v10, v83, v35
    v_fma_f32 v36, v10, v84, v36
    v_fma_f32 v37, v10, v85, v37
    v_fma_f32 v38, v10, v86, v38
    v_fma_f32 v39, v10, v87, v39
    v_fma_f32 v40, v11, v80, v40
    v_fma_f32 v41, v11, v81, v41
    v_fma_f32 v42, v11, v82, v42
    v_fma_f32 v43, v11, v83, v43
    v_fma_f32 v44, v11, v84, v44
    v_fma_f32 v45, v11, v85, v45
    v_fma_f32 v46, v11, v86, v46
    v_fma_f32 v47, v11, v87, v47
    ds_read_b128 v[8:11], v5 offset:2176
    v_lshlrev_b32 v80, 16, v56
    v_and_b32 v81, 0xffff0000, v56
    v_lshlrev_b32 v82, 16, v57
    v_and_b32 v83, 0xffff0000, v57
    v_lshlrev_b32 v84, 16, v58
    v_and_b32 v85, 0xffff0000, v58
    v_lshlrev_b32 v86, 16, v59
    v_and_b32 v87, 0xffff0000, v59
    s_waitcnt lgkmcnt(0)
    v_fma_f32 v16, v8, v80, v16
    v_fma_f32 v17, v8, v81, v17
    v_fma_f32 v18, v8, v82, v18
    v_fma_f32 v19, v8, v83, v19
    v_fma_f32 v20, v8, v84, v20
    v_fma_f32 v21, v8, v85, v21
    v_fma_f32 v22, v8, v86, v22
    v_fma_f32 v23, v8, v87, v23
    v_fma_f32 v24, v9, v80, v24
    v_fma_f32 v25, v9, v81, v25
    v_fma_f32 v26, v9, v82, v26
    v_fma_f32 v27, v9, v83, v27
    v_fma_f32 v28, v9, v84, v28
    v_fma_f32 v29, v9, v85, v29
    v_fma_f32 v30, v9, v86, v30
    v_fma_f32 v31, v9, v87, v31
    v_fma_f32 v32, v10, v80, v32
    v_fma_f32 v33, v10, v81, v33
    v_fma_f32 v34, v10, v82, v34
    v_fma_f32 v35, v10, v83, v35
    v_fma_f32 v36, v10, v84, v36
    v_fma_f32 v37, v10, v85, v37
    v_fma_f32 v38, v10, v86, v38
    v_fma_f32 v39, v10, v87, v39
    v_fma_f32 v40, v11, v80, v40
    v_fma_f32 v41, v11, v81, v41
    v_fma_f32 v42, v11, v82, v42
    v_fma_f32 v43, v11, v83, v43
    v_fma_f32 v44, v11, v84, v44
    v_fma_f32 v45, v11, v85, v45
    v_fma_f32 v46, v11, v86, v46
    v_fma_f32 v47, v11, v87, v47
    ds_read_b128 v[8:11], v5 offset:2240
    v_lshlrev_b32 v80, 16, v60
    v_and_b32 v81, 0xffff0000, v60
    v_lshlrev_b32 v82, 16, v61
    v_and_b32 v83, 0xffff0000, v61
    v_lshlrev_b32 v84, 16, v62
    v_and_b32 v85, 0xffff0000, v62
    v_lshlrev_b32 v86, 16, v63
    v_and_b32 v87, 0xffff0000, v63
    s_waitcnt lgkmcnt(0)
    v_fma_f32 v16, v8, v80, v16
    v_fma_f32 v17, v8, v81, v17
    v_fma_f32 v18, v8, v82, v18
    v_fma_f32 v19, v8, v83, v19
    v_fma_f32 v20, v8, v84, v20
    v_fma_f32 v21, v8, v85, v21
    v_fma_f32 v22, v8, v86, v22
    v_fma_f32 v23, v8, v87, v23
    v_fma_f32 v24, v9, v80, v24
    v_fma_f32 v25, v9, v81, v25
    v_fma_f32 v26, v9, v82, v26
    v_fma_f32 v27, v9, v83, v27
    v_fma_f32 v28, v9, v84, v28
    v_fma_f32 v29, v9, v85, v29
    v_fma_f32 v30, v9, v86, v30
    v_fma_f32 v31, v9, v87, v31
    v_fma_f32 v32, v10, v80, v32
    v_fma_f32 v33, v10, v81, v33
    v_fma_f32 v34, v10, v82, v34
    v_fma_f32 v35, v10, v83, v35
    v_fma_f32 v36, v10, v84, v36
    v_fma_f32 v37, v10, v85, v37
    v_fma_f32 v38, v10, v86, v38
    v_fma_f32 v39, v10, v87, v39
    v_fma_f32 v40, v11, v80, v40
    v_fma_f32 v41, v11, v81, v41
    v_fma_f32 v42, v11, v82, v42
    v_fma_f32 v43, v11, v83, v43
    v_fma_f32 v44, v11, v84, v44
    v_fma_f32 v45, v11, v85, v45
    v_fma_f32 v46, v11, v86, v46
    v_fma_f32 v47, v11, v87, v47
    ds_read_b128 v[8:11], v5 offset:2304
    v_lshlrev_b32 v80, 16, v64
    v_and_b32 v81, 0xffff0000, v64
    v_lshlrev_b32 v82, 16, v65
    v_and_b32 v83, 0xffff0000, v65
    v_lshlrev_b32 v84, 16, v66
    v_and_b32 v85, 0xffff0000, v66
    v_lshlrev_b32 v86, 16, v67
    v_and_b32 v87, 0xffff0000, v67
    s_waitcnt lgkmcnt(0)
    v_fma_f32 v16, v8, v80, v16
    v_fma_f32 v17, v8, v81, v17
    v_fma_f32 v18, v8, v82, v18
    v_fma_f32 v19, v8, v83, v19
    v_fma_f32 v20, v8, v84, v20
    v_fma_f32 v21, v8, v85, v21
    v_fma_f32 v22, v8, v86, v22
    v_fma_f32 v23, v8, v87, v23
    v_fma_f32 v24, v9, v80, v24
    v_fma_f32 v25, v9, v81, v25
    v_fma_f32 v26, v9, v82, v26
    v_fma_f32 v27, v9, v83, v27
    v_fma_f32 v28, v9, v84, v28
    v_fma_f32 v29, v9, v85, v29
    v_fma_f32 v30, v9, v86, v30
    v_fma_f32 v31, v9, v87, v31
    v_fma_f32 v32, v10, v80, v32
    v_fma_f32 v33, v10, v81, v33
    v_fma_f32 v34, v10, v82, v34
    v_fma_f32 v35, v10, v83, v35
    v_fma_f32 v36, v10, v84, v36
    v_fma_f32 v37, v10, v85, v37
    v_fma_f32 v38, v10, v86, v38
    v_fma_f32 v39, v10, v87, v39
    v_fma_f32 v40, v11, v80, v40
    v_fma_f32 v41, v11, v81, v41
    v_fma_f32 v42, v11, v82, v42
    v_fma_f32 v43, v11, v83, v43
    v_fma_f32 v44, v11, v84, v44
    v_fma_f32 v45, v11, v85, v45
    v_fma_f32 v46, v11, v86, v46
    v_fma_f32 v47, v11, v87, v47
    ds_read_b128 v[8:11], v5 offset:2368
    v_lshlrev_b32 v80, 16, v68
    v_and_b32 v81, 0xffff0000, v68
    v_lshlrev_b32 v82, 16, v69
    v_and_b32 v83, 0xffff0000, v69
    v_lshlrev_b32 v84, 16, v70
    v_and_b32 v85, 0xffff0000, v70
    v_lshlrev_b32 v86, 16, v71
    v_and_b32 v87, 0xffff0000, v71
    s_waitcnt lgkmcnt(0)
    v_fma_f32 v16, v8, v80, v16
    v_fma_f32 v17, v8, v81, v17
    v_fma_f32 v18, v8, v82, v18
    v_fma_f32 v19, v8, v83, v19
    v_fma_f32 v20, v8, v84, v20
    v_fma_f32 v21, v8, v85, v21
    v_fma_f32 v22, v8, v86, v22
    v_fma_f32 v23, v8, v87, v23
    v_fma_f32 v24, v9, v80, v24
    v_fma_f32 v25, v9, v81, v25
    v_fma_f32 v26, v9, v82, v26
    v_fma_f32 v27, v9, v83, v27
    v_fma_f32 v28, v9, v84, v28
    v_fma_f32 v29, v9, v85, v29
    v_fma_f32 v30, v9, v86, v30
    v_fma_f32 v31, v9, v87, v31
    v_fma_f32 v32, v10, v80, v32
    v_fma_f32 v33, v10, v81, v33
    v_fma_f32 v34, v10, v82, v34
    v_fma_f32 v35, v10, v83, v35
    v_fma_f32 v36, v10, v84, v36
    v_fma_f32 v37, v10, v85, v37
    v_fma_f32 v38, v10, v86, v38
    v_fma_f32 v39, v10, v87, v39
    v_fma_f32 v40, v11, v80, v40
    v_fma_f32 v41, v11, v81, v41
    v_fma_f32 v42, v11, v82, v42
    v_fma_f32 v43, v11, v83, v43
    v_fma_f32 v44, v11, v84, v44
    v_fma_f32 v45, v11, v85, v45
    v_fma_f32 v46, v11, v86, v46
    v_fma_f32 v47, v11, v87, v47
    ds_read_b128 v[8:11], v5 offset:2432
    v_lshlrev_b32 v80, 16, v72
    v_and_b32 v81, 0xffff0000, v72
    v_lshlrev_b32 v82, 16, v73
    v_and_b32 v83, 0xffff0000, v73
    v_lshlrev_b32 v84, 16, v74
    v_and_b32 v85, 0xffff0000, v74
    v_lshlrev_b32 v86, 16, v75
    v_and_b32 v87, 0xffff0000, v75
    s_waitcnt lgkmcnt(0)
    v_fma_f32 v16, v8, v80, v16
    v_fma_f32 v17, v8, v81, v17
    v_fma_f32 v18, v8, v82, v18
    v_fma_f32 v19, v8, v83, v19
    v_fma_f32 v20, v8, v84, v20
    v_fma_f32 v21, v8, v85, v21
    v_fma_f32 v22, v8, v86, v22
    v_fma_f32 v23, v8, v87, v23
    v_fma_f32 v24, v9, v80, v24
    v_fma_f32 v25, v9, v81, v25
    v_fma_f32 v26, v9, v82, v26
    v_fma_f32 v27, v9, v83, v27
    v_fma_f32 v28, v9, v84, v28
    v_fma_f32 v29, v9, v85, v29
    v_fma_f32 v30, v9, v86, v30
    v_fma_f32 v31, v9, v87, v31
    v_fma_f32 v32, v10, v80, v32
    v_fma_f32 v33, v10, v81, v33
    v_fma_f32 v34, v10, v82, v34
    v_fma_f32 v35, v10, v83, v35
    v_fma_f32 v36, v10, v84, v36
    v_fma_f32 v37, v10, v85, v37
    v_fma_f32 v38, v10, v86, v38
    v_fma_f32 v39, v10, v87, v39
    v_fma_f32 v40, v11, v80, v40
    v_fma_f32 v41, v11, v81, v41
    v_fma_f32 v42, v11, v82, v42
    v_fma_f32 v43, v11, v83, v43
    v_fma_f32 v44, v11, v84, v44
    v_fma_f32 v45, v11, v85, v45
    v_fma_f32 v46, v11, v86, v46
    v_fma_f32 v47, v11, v87, v47
    ds_read_b128 v[8:11], v5 offset:2496
    v_lshlrev_b32 v80, 16, v76
    v_and_b32 v81, 0xffff0000, v76
    v_lshlrev_b32 v82, 16, v77
    v_and_b32 v83, 0xffff0000, v77
    v_lshlrev_b32 v84, 16, v78
    v_and_b32 v85, 0xffff0000, v78
    v_lshlrev_b32 v86, 16, v79
    v_and_b32 v87, 0xffff0000, v79
    s_waitcnt lgkmcnt(0)
    v_fma_f32 v16, v8, v80, v16
    v_fma_f32 v17, v8, v81, v17
    v_fma_f32 v18, v8, v82, v18
    v_fma_f32 v19, v8, v83, v19
    v_fma_f32 v20, v8, v84, v20
    v_fma_f32 v21, v8, v85, v21
    v_fma_f32 v22, v8, v86, v22
    v_fma_f32 v23, v8, v87, v23
    v_fma_f32 v24, v9, v80, v24
    v_fma_f32 v25, v9, v81, v25
    v_fma_f32 v26, v9, v82, v26
    v_fma_f32 v27, v9, v83, v27
    v_fma_f32 v28, v9, v84, v28
    v_fma_f32 v29, v9, v85, v29
    v_fma_f32 v30, v9, v86, v30
    v_fma_f32 v31, v9, v87, v31
    v_fma_f32 v32, v10, v80, v32
    v_fma_f32 v33, v10, v81, v33
    v_fma_f32 v34, v10, v82, v34
    v_fma_f32 v35, v10, v83, v35
    v_fma_f32 v36, v10, v84, v36
    v_fma_f32 v37, v10, v85, v37
    v_fma_f32 v38, v10, v86, v38
    v_fma_f32 v39, v10, v87, v39
    v_fma_f32 v40, v11, v80, v40
    v_fma_f32 v41, v11, v81, v41
    v_fma_f32 v42, v11, v82, v42
    v_fma_f32 v43, v11, v83, v43
    v_fma_f32 v44, v11, v84, v44
    v_fma_f32 v45, v11, v85, v45
    v_fma_f32 v46, v11, v86, v46
    v_fma_f32 v47, v11, v87, v47
    v_lshl_add_u32 v5, v2, 2, v4
    v_lshlrev_b32 v5, 11, v5
    v_lshl_add_u32 v5, v3, 5, v5
    ds_write_b128 v5, v[16:19] offset:4096
    ds_write_b128 v5, v[20:23] offset:4112
    ds_write_b128 v5, v[24:27] offset:4608
    ds_write_b128 v5, v[28:31] offset:4624
    ds_write_b128 v5, v[32:35] offset:5120
    ds_write_b128 v5, v[36:39] offset:5136
    ds_write_b128 v5, v[40:43] offset:5632
    ds_write_b128 v5, v[44:47] offset:5648
    s_waitcnt lgkmcnt(0)
    s_barrier
    v_lshlrev_b32 v5, 3, v0
    ds_read_b64 v[16:17], v5 offset:4096
    ds_read_b64 v[18:19], v5 offset:6144
    ds_read_b64 v[20:21], v5 offset:8192
    ds_read_b64 v[22:23], v5 offset:10240
    ds_read_b64 v[24:25], v5 offset:12288
    ds_read_b64 v[26:27], v5 offset:14336
    ds_read_b64 v[28:29], v5 offset:16384
    ds_read_b64 v[30:31], v5 offset:18432
    ds_read_b64 v[32:33], v5 offset:20480
    ds_read_b64 v[34:35], v5 offset:22528
    ds_read_b64 v[36:37], v5 offset:24576
    ds_read_b64 v[38:39], v5 offset:26624
    ds_read_b64 v[40:41], v5 offset:28672
    ds_read_b64 v[42:43], v5 offset:30720
    ds_read_b64 v[44:45], v5 offset:32768
    ds_read_b64 v[46:47], v5 offset:34816
    s_waitcnt lgkmcnt(0)
    v_add_f32 v16, v16, v18
    v_add_f32 v17, v17, v19
    v_add_f32 v16, v16, v20
    v_add_f32 v17, v17, v21
    v_add_f32 v16, v16, v22
    v_add_f32 v17, v17, v23
    v_add_f32 v16, v16, v24
    v_add_f32 v17, v17, v25
    v_add_f32 v16, v16, v26
    v_add_f32 v17, v17, v27
    v_add_f32 v16, v16, v28
    v_add_f32 v17, v17, v29
    v_add_f32 v16, v16, v30
    v_add_f32 v17, v17, v31
    v_add_f32 v16, v16, v32
    v_add_f32 v17, v17, v33
    v_add_f32 v16, v16, v34
    v_add_f32 v17, v17, v35
    v_add_f32 v16, v16, v36
    v_add_f32 v17, v17, v37
    v_add_f32 v16, v16, v38
    v_add_f32 v17, v17, v39
    v_add_f32 v16, v16, v40
    v_add_f32 v17, v17, v41
    v_add_f32 v16, v16, v42
    v_add_f32 v17, v17, v43
    v_add_f32 v16, v16, v44
    v_add_f32 v17, v17, v45
    v_add_f32 v16, v16, v46
    v_add_f32 v17, v17, v47
    s_lshl_b32 s25, s2, 11
    s_add_u32 s25, s25, 262144
    buffer_store_dwordx2 v[16:17], v5, s[16:19], s25 offen
K2_END:
    s_endpgm
.globl k3_kernel
.p2align 8
.type k3_kernel,@function
k3_kernel:
    s_cmp_ge_u32 s2, 368
    s_cbranch_scc1 K3_END
    s_load_dwordx2 s[4:5], s[0:1], 32
    s_load_dwordx2 s[6:7], s[0:1], 64
    s_load_dwordx2 s[28:29], s[0:1], 96
    v_and_b32 v1, 63, v0
    v_lshrrev_b32 v2, 6, v0
    s_lshr_b32 s20, s2, 3
    s_and_b32 s21, s2, 7
    s_waitcnt lgkmcnt(0)
    s_cmp_ge_u32 s20, 32
    s_cselect_b32 s12, s6, s4
    s_cselect_b32 s13, s7, s5
    s_mov_b32 s14, 4194304
    s_cselect_b32 s14, 1835008, s14
    s_mov_b32 s15, 0x00020000
    s_and_b32 s22, s20, 31
    s_lshl_b32 s22, s22, 17
    s_lshl_b32 s23, s21, 7
    s_add_u32 s22, s22, s23
    s_mov_b32 s16, s28
    s_mov_b32 s17, s29
    s_mov_b32 s18, 268435456
    s_mov_b32 s19, 0x00020000
    v_lshrrev_b32 v3, 5, v1
    v_lshl_add_u32 v3, v2, 5, v3
    v_lshlrev_b32 v3, 10, v3
    v_and_b32 v4, 31, v1
    v_lshl_add_u32 v3, v4, 2, v3
    buffer_load_dword v64, v3, s[12:15], s22 offen offset:0
    buffer_load_dword v65, v3, s[12:15], s22 offen offset:2048
    s_add_u32 s22, s22, 4096
    buffer_load_dword v66, v3, s[12:15], s22 offen offset:0
    buffer_load_dword v67, v3, s[12:15], s22 offen offset:2048
    s_add_u32 s22, s22, 4096
    buffer_load_dword v68, v3, s[12:15], s22 offen offset:0
    buffer_load_dword v69, v3, s[12:15], s22 offen offset:2048
    s_add_u32 s22, s22, 4096
    buffer_load_dword v70, v3, s[12:15], s22 offen offset:0
    buffer_load_dword v71, v3, s[12:15], s22 offen offset:2048
    s_add_u32 s22, s22, 4096
    buffer_load_dword v72, v3, s[12:15], s22 offen offset:0
    buffer_load_dword v73, v3, s[12:15], s22 offen offset:2048
    s_add_u32 s22, s22, 4096
    buffer_load_dword v74, v3, s[12:15], s22 offen offset:0
    buffer_load_dword v75, v3, s[12:15], s22 offen offset:2048
    s_add_u32 s22, s22, 4096
    buffer_load_dword v76, v3, s[12:15], s22 offen offset:0
    buffer_load_dword v77, v3, s[12:15], s22 offen offset:2048
    s_add_u32 s22, s22, 4096
    buffer_load_dword v78, v3, s[12:15], s22 offen offset:0
    buffer_load_dword v79, v3, s[12:15], s22 offen offset:2048
    s_add_u32 s22, s22, 4096
    s_cmp_ge_u32 s20, 32
    s_cbranch_scc1 K3_FFN
    v_lshrrev_b32 v5, 5, v0
    v_and_b32 v6, 31, v0
    s_lshr_b32 s24, s20, 2
    s_and_b32 s25, s20, 3
    v_lshlrev_b32 v7, 3, v5
    v_add_u32 v7, s24, v7
    v_lshlrev_b32 v7, 5, v7
    v_add_u32 v7, s25, v7
    v_lshlrev_b32 v8, 3, v7
    v_lshlrev_b32 v9, 9, v7
    v_lshl_add_u32 v9, v6, 4, v9
    s_mov_b32 s26, 131072
    s_mov_b32 s27, 262144
    buffer_load_dwordx2 v[16:17], v8, s[16:19], s26 offen offset:0
    buffer_load_dwordx2 v[18:19], v8, s[16:19], s26 offen offset:32
    buffer_load_dwordx2 v[20:21], v8, s[16:19], s26 offen offset:64
    buffer_load_dwordx2 v[22:23], v8, s[16:19], s26 offen offset:96
    buffer_load_dwordx2 v[24:25], v8, s[16:19], s26 offen offset:128
    buffer_load_dwordx2 v[26:27], v8, s[16:19], s26 offen offset:160
    buffer_load_dwordx2 v[28:29], v8, s[16:19], s26 offen offset:192
    buffer_load_dwordx2 v[30:31], v8, s[16:19], s26 offen offset:224
    buffer_load_dwordx4 v[32:35], v9, s[16:19], s27 offen offset:0
    buffer_load_dwordx4 v[36:39], v9, s[16:19], s27 offen offset:2048
    s_add_u32 s27, s27, 4096
    buffer_load_dwordx4 v[40:43], v9, s[16:19], s27 offen offset:0
    buffer_load_dwordx4 v[44:47], v9, s[16:19], s27 offen offset:2048
    s_add_u32 s27, s27, 4096
    buffer_load_dwordx4 v[48:51], v9, s[16:19], s27 offen offset:0
    buffer_load_dwordx4 v[52:55], v9, s[16:19], s27 offen offset:2048
    s_add_u32 s27, s27, 4096
    buffer_load_dwordx4 v[56:59], v9, s[16:19], s27 offen offset:0
    buffer_load_dwordx4 v[60:63], v9, s[16:19], s27 offen offset:2048
    s_add_u32 s27, s27, 4096
    s_waitcnt vmcnt(8)
    v_mov_b32 v10, v16
    v_max_f32 v10, v10, v18
    v_max_f32 v10, v10, v20
    v_max_f32 v10, v10, v22
    v_max_f32 v10, v10, v24
    v_max_f32 v10, v10, v26
    v_max_f32 v10, v10, v28
    v_max_f32 v10, v10, v30
    v_mov_b32 v11, 0
    v_sub_f32 v16, v16, v10
    v_mul_f32 v16, 0x3fb8aa3b, v16
    v_exp_f32 v16, v16
    s_nop 0
    v_fma_f32 v11, v16, v17, v11
    v_sub_f32 v18, v18, v10
    v_mul_f32 v18, 0x3fb8aa3b, v18
    v_exp_f32 v18, v18
    s_nop 0
    v_fma_f32 v11, v18, v19, v11
    v_sub_f32 v20, v20, v10
    v_mul_f32 v20, 0x3fb8aa3b, v20
    v_exp_f32 v20, v20
    s_nop 0
    v_fma_f32 v11, v20, v21, v11
    v_sub_f32 v22, v22, v10
    v_mul_f32 v22, 0x3fb8aa3b, v22
    v_exp_f32 v22, v22
    s_nop 0
    v_fma_f32 v11, v22, v23, v11
    v_sub_f32 v24, v24, v10
    v_mul_f32 v24, 0x3fb8aa3b, v24
    v_exp_f32 v24, v24
    s_nop 0
    v_fma_f32 v11, v24, v25, v11
    v_sub_f32 v26, v26, v10
    v_mul_f32 v26, 0x3fb8aa3b, v26
    v_exp_f32 v26, v26
    s_nop 0
    v_fma_f32 v11, v26, v27, v11
    v_sub_f32 v28, v28, v10
    v_mul_f32 v28, 0x3fb8aa3b, v28
    v_exp_f32 v28, v28
    s_nop 0
    v_fma_f32 v11, v28, v29, v11
    v_sub_f32 v30, v30, v10
    v_mul_f32 v30, 0x3fb8aa3b, v30
    v_exp_f32 v30, v30
    s_nop 0
    v_fma_f32 v11, v30, v31, v11
    v_rcp_f32 v11, v11
    s_waitcnt vmcnt(0)
    v_mul_f32 v12, v16, v32
    v_mul_f32 v13, v16, v33
    v_mul_f32 v14, v16, v34
    v_mul_f32 v15, v16, v35
    v_fma_f32 v12, v18, v36, v12
    v_fma_f32 v13, v18, v37, v13
    v_fma_f32 v14, v18, v38, v14
    v_fma_f32 v15, v18, v39, v15
    v_fma_f32 v12, v20, v40, v12
    v_fma_f32 v13, v20, v41, v13
    v_fma_f32 v14, v20, v42, v14
    v_fma_f32 v15, v20, v43, v15
    v_fma_f32 v12, v22, v44, v12
    v_fma_f32 v13, v22, v45, v13
    v_fma_f32 v14, v22, v46, v14
    v_fma_f32 v15, v22, v47, v15
    v_fma_f32 v12, v24, v48, v12
    v_fma_f32 v13, v24, v49, v13
    v_fma_f32 v14, v24, v50, v14
    v_fma_f32 v15, v24, v51, v15
    v_fma_f32 v12, v26, v52, v12
    v_fma_f32 v13, v26, v53, v13
    v_fma_f32 v14, v26, v54, v14
    v_fma_f32 v15, v26, v55, v15
    v_fma_f32 v12, v28, v56, v12
    v_fma_f32 v13, v28, v57, v13
    v_fma_f32 v14, v28, v58, v14
    v_fma_f32 v15, v28, v59, v15
    v_fma_f32 v12, v30, v60, v12
    v_fma_f32 v13, v30, v61, v13
    v_fma_f32 v14, v30, v62, v14
    v_fma_f32 v15, v30, v63, v15
    v_mul_f32 v12, v12, v11
    v_cvt_pk_bf16_f32 v12, v12, v12
    v_lshlrev_b32 v12, 16, v12
    v_mul_f32 v13, v13, v11
    v_cvt_pk_bf16_f32 v13, v13, v13
    v_lshlrev_b32 v13, 16, v13
    v_mul_f32 v14, v14, v11
    v_cvt_pk_bf16_f32 v14, v14, v14
    v_lshlrev_b32 v14, 16, v14
    v_mul_f32 v15, v15, v11
    v_cvt_pk_bf16_f32 v15, v15, v15
    v_lshlrev_b32 v15, 16, v15
    s_branch K3_WR
K3_FFN:
    v_lshrrev_b32 v5, 5, v0
    v_and_b32 v6, 31, v0
    v_mul_u32_u24 v9, 7168, v5
    v_lshl_add_u32 v9, v6, 4, v9
    s_sub_u32 s24, s20, 32
    s_lshl_b32 s24, s24, 9
    s_add_u32 s24, s24, 65536
    buffer_load_dwordx4 v[12:15], v9, s[16:19], s24 offen
    s_waitcnt vmcnt(0)
K3_WR:
    v_lshlrev_b32 v7, 7, v6
    v_lshl_add_u32 v7, v5, 2, v7
    ds_write_b32 v7, v12 offset:0
    ds_write_b32 v7, v13 offset:32
    ds_write_b32 v7, v14 offset:64
    ds_write_b32 v7, v15 offset:96
    s_waitcnt lgkmcnt(0)
    s_barrier
    v_mov_b32 v32, 0
    v_mov_b32 v33, 0
    v_mov_b32 v34, 0
    v_mov_b32 v35, 0
    v_mov_b32 v36, 0
    v_mov_b32 v37, 0
    v_mov_b32 v38, 0
    v_mov_b32 v39, 0
    v_mov_b32 v40, 0
    v_mov_b32 v41, 0
    v_mov_b32 v42, 0
    v_mov_b32 v43, 0
    v_mov_b32 v44, 0
    v_mov_b32 v45, 0
    v_mov_b32 v46, 0
    v_mov_b32 v47, 0
    v_lshrrev_b32 v7, 5, v1
    v_lshl_add_u32 v7, v2, 5, v7
    v_lshlrev_b32 v7, 5, v7
    ds_read_b128 v[16:19], v7 offset:0
    ds_read_b128 v[20:23], v7 offset:16
    v_lshlrev_b32 v24, 16, v64
    v_and_b32 v25, 0xffff0000, v64
    s_waitcnt lgkmcnt(0)
    v_fma_f32 v32, v16, v24, v32
    v_fma_f32 v33, v16, v25, v33
    v_fma_f32 v34, v17, v24, v34
    v_fma_f32 v35, v17, v25, v35
    v_fma_f32 v36, v18, v24, v36
    v_fma_f32 v37, v18, v25, v37
    v_fma_f32 v38, v19, v24, v38
    v_fma_f32 v39, v19, v25, v39
    v_fma_f32 v40, v20, v24, v40
    v_fma_f32 v41, v20, v25, v41
    v_fma_f32 v42, v21, v24, v42
    v_fma_f32 v43, v21, v25, v43
    v_fma_f32 v44, v22, v24, v44
    v_fma_f32 v45, v22, v25, v45
    v_fma_f32 v46, v23, v24, v46
    v_fma_f32 v47, v23, v25, v47
    ds_read_b128 v[16:19], v7 offset:64
    ds_read_b128 v[20:23], v7 offset:80
    v_lshlrev_b32 v24, 16, v65
    v_and_b32 v25, 0xffff0000, v65
    s_waitcnt lgkmcnt(0)
    v_fma_f32 v32, v16, v24, v32
    v_fma_f32 v33, v16, v25, v33
    v_fma_f32 v34, v17, v24, v34
    v_fma_f32 v35, v17, v25, v35
    v_fma_f32 v36, v18, v24, v36
    v_fma_f32 v37, v18, v25, v37
    v_fma_f32 v38, v19, v24, v38
    v_fma_f32 v39, v19, v25, v39
    v_fma_f32 v40, v20, v24, v40
    v_fma_f32 v41, v20, v25, v41
    v_fma_f32 v42, v21, v24, v42
    v_fma_f32 v43, v21, v25, v43
    v_fma_f32 v44, v22, v24, v44
    v_fma_f32 v45, v22, v25, v45
    v_fma_f32 v46, v23, v24, v46
    v_fma_f32 v47, v23, v25, v47
    ds_read_b128 v[16:19], v7 offset:128
    ds_read_b128 v[20:23], v7 offset:144
    v_lshlrev_b32 v24, 16, v66
    v_and_b32 v25, 0xffff0000, v66
    s_waitcnt lgkmcnt(0)
    v_fma_f32 v32, v16, v24, v32
    v_fma_f32 v33, v16, v25, v33
    v_fma_f32 v34, v17, v24, v34
    v_fma_f32 v35, v17, v25, v35
    v_fma_f32 v36, v18, v24, v36
    v_fma_f32 v37, v18, v25, v37
    v_fma_f32 v38, v19, v24, v38
    v_fma_f32 v39, v19, v25, v39
    v_fma_f32 v40, v20, v24, v40
    v_fma_f32 v41, v20, v25, v41
    v_fma_f32 v42, v21, v24, v42
    v_fma_f32 v43, v21, v25, v43
    v_fma_f32 v44, v22, v24, v44
    v_fma_f32 v45, v22, v25, v45
    v_fma_f32 v46, v23, v24, v46
    v_fma_f32 v47, v23, v25, v47
    ds_read_b128 v[16:19], v7 offset:192
    ds_read_b128 v[20:23], v7 offset:208
    v_lshlrev_b32 v24, 16, v67
    v_and_b32 v25, 0xffff0000, v67
    s_waitcnt lgkmcnt(0)
    v_fma_f32 v32, v16, v24, v32
    v_fma_f32 v33, v16, v25, v33
    v_fma_f32 v34, v17, v24, v34
    v_fma_f32 v35, v17, v25, v35
    v_fma_f32 v36, v18, v24, v36
    v_fma_f32 v37, v18, v25, v37
    v_fma_f32 v38, v19, v24, v38
    v_fma_f32 v39, v19, v25, v39
    v_fma_f32 v40, v20, v24, v40
    v_fma_f32 v41, v20, v25, v41
    v_fma_f32 v42, v21, v24, v42
    v_fma_f32 v43, v21, v25, v43
    v_fma_f32 v44, v22, v24, v44
    v_fma_f32 v45, v22, v25, v45
    v_fma_f32 v46, v23, v24, v46
    v_fma_f32 v47, v23, v25, v47
    ds_read_b128 v[16:19], v7 offset:256
    ds_read_b128 v[20:23], v7 offset:272
    v_lshlrev_b32 v24, 16, v68
    v_and_b32 v25, 0xffff0000, v68
    s_waitcnt lgkmcnt(0)
    v_fma_f32 v32, v16, v24, v32
    v_fma_f32 v33, v16, v25, v33
    v_fma_f32 v34, v17, v24, v34
    v_fma_f32 v35, v17, v25, v35
    v_fma_f32 v36, v18, v24, v36
    v_fma_f32 v37, v18, v25, v37
    v_fma_f32 v38, v19, v24, v38
    v_fma_f32 v39, v19, v25, v39
    v_fma_f32 v40, v20, v24, v40
    v_fma_f32 v41, v20, v25, v41
    v_fma_f32 v42, v21, v24, v42
    v_fma_f32 v43, v21, v25, v43
    v_fma_f32 v44, v22, v24, v44
    v_fma_f32 v45, v22, v25, v45
    v_fma_f32 v46, v23, v24, v46
    v_fma_f32 v47, v23, v25, v47
    ds_read_b128 v[16:19], v7 offset:320
    ds_read_b128 v[20:23], v7 offset:336
    v_lshlrev_b32 v24, 16, v69
    v_and_b32 v25, 0xffff0000, v69
    s_waitcnt lgkmcnt(0)
    v_fma_f32 v32, v16, v24, v32
    v_fma_f32 v33, v16, v25, v33
    v_fma_f32 v34, v17, v24, v34
    v_fma_f32 v35, v17, v25, v35
    v_fma_f32 v36, v18, v24, v36
    v_fma_f32 v37, v18, v25, v37
    v_fma_f32 v38, v19, v24, v38
    v_fma_f32 v39, v19, v25, v39
    v_fma_f32 v40, v20, v24, v40
    v_fma_f32 v41, v20, v25, v41
    v_fma_f32 v42, v21, v24, v42
    v_fma_f32 v43, v21, v25, v43
    v_fma_f32 v44, v22, v24, v44
    v_fma_f32 v45, v22, v25, v45
    v_fma_f32 v46, v23, v24, v46
    v_fma_f32 v47, v23, v25, v47
    ds_read_b128 v[16:19], v7 offset:384
    ds_read_b128 v[20:23], v7 offset:400
    v_lshlrev_b32 v24, 16, v70
    v_and_b32 v25, 0xffff0000, v70
    s_waitcnt lgkmcnt(0)
    v_fma_f32 v32, v16, v24, v32
    v_fma_f32 v33, v16, v25, v33
    v_fma_f32 v34, v17, v24, v34
    v_fma_f32 v35, v17, v25, v35
    v_fma_f32 v36, v18, v24, v36
    v_fma_f32 v37, v18, v25, v37
    v_fma_f32 v38, v19, v24, v38
    v_fma_f32 v39, v19, v25, v39
    v_fma_f32 v40, v20, v24, v40
    v_fma_f32 v41, v20, v25, v41
    v_fma_f32 v42, v21, v24, v42
    v_fma_f32 v43, v21, v25, v43
    v_fma_f32 v44, v22, v24, v44
    v_fma_f32 v45, v22, v25, v45
    v_fma_f32 v46, v23, v24, v46
    v_fma_f32 v47, v23, v25, v47
    ds_read_b128 v[16:19], v7 offset:448
    ds_read_b128 v[20:23], v7 offset:464
    v_lshlrev_b32 v24, 16, v71
    v_and_b32 v25, 0xffff0000, v71
    s_waitcnt lgkmcnt(0)
    v_fma_f32 v32, v16, v24, v32
    v_fma_f32 v33, v16, v25, v33
    v_fma_f32 v34, v17, v24, v34
    v_fma_f32 v35, v17, v25, v35
    v_fma_f32 v36, v18, v24, v36
    v_fma_f32 v37, v18, v25, v37
    v_fma_f32 v38, v19, v24, v38
    v_fma_f32 v39, v19, v25, v39
    v_fma_f32 v40, v20, v24, v40
    v_fma_f32 v41, v20, v25, v41
    v_fma_f32 v42, v21, v24, v42
    v_fma_f32 v43, v21, v25, v43
    v_fma_f32 v44, v22, v24, v44
    v_fma_f32 v45, v22, v25, v45
    v_fma_f32 v46, v23, v24, v46
    v_fma_f32 v47, v23, v25, v47
    ds_read_b128 v[16:19], v7 offset:512
    ds_read_b128 v[20:23], v7 offset:528
    v_lshlrev_b32 v24, 16, v72
    v_and_b32 v25, 0xffff0000, v72
    s_waitcnt lgkmcnt(0)
    v_fma_f32 v32, v16, v24, v32
    v_fma_f32 v33, v16, v25, v33
    v_fma_f32 v34, v17, v24, v34
    v_fma_f32 v35, v17, v25, v35
    v_fma_f32 v36, v18, v24, v36
    v_fma_f32 v37, v18, v25, v37
    v_fma_f32 v38, v19, v24, v38
    v_fma_f32 v39, v19, v25, v39
    v_fma_f32 v40, v20, v24, v40
    v_fma_f32 v41, v20, v25, v41
    v_fma_f32 v42, v21, v24, v42
    v_fma_f32 v43, v21, v25, v43
    v_fma_f32 v44, v22, v24, v44
    v_fma_f32 v45, v22, v25, v45
    v_fma_f32 v46, v23, v24, v46
    v_fma_f32 v47, v23, v25, v47
    ds_read_b128 v[16:19], v7 offset:576
    ds_read_b128 v[20:23], v7 offset:592
    v_lshlrev_b32 v24, 16, v73
    v_and_b32 v25, 0xffff0000, v73
    s_waitcnt lgkmcnt(0)
    v_fma_f32 v32, v16, v24, v32
    v_fma_f32 v33, v16, v25, v33
    v_fma_f32 v34, v17, v24, v34
    v_fma_f32 v35, v17, v25, v35
    v_fma_f32 v36, v18, v24, v36
    v_fma_f32 v37, v18, v25, v37
    v_fma_f32 v38, v19, v24, v38
    v_fma_f32 v39, v19, v25, v39
    v_fma_f32 v40, v20, v24, v40
    v_fma_f32 v41, v20, v25, v41
    v_fma_f32 v42, v21, v24, v42
    v_fma_f32 v43, v21, v25, v43
    v_fma_f32 v44, v22, v24, v44
    v_fma_f32 v45, v22, v25, v45
    v_fma_f32 v46, v23, v24, v46
    v_fma_f32 v47, v23, v25, v47
    ds_read_b128 v[16:19], v7 offset:640
    ds_read_b128 v[20:23], v7 offset:656
    v_lshlrev_b32 v24, 16, v74
    v_and_b32 v25, 0xffff0000, v74
    s_waitcnt lgkmcnt(0)
    v_fma_f32 v32, v16, v24, v32
    v_fma_f32 v33, v16, v25, v33
    v_fma_f32 v34, v17, v24, v34
    v_fma_f32 v35, v17, v25, v35
    v_fma_f32 v36, v18, v24, v36
    v_fma_f32 v37, v18, v25, v37
    v_fma_f32 v38, v19, v24, v38
    v_fma_f32 v39, v19, v25, v39
    v_fma_f32 v40, v20, v24, v40
    v_fma_f32 v41, v20, v25, v41
    v_fma_f32 v42, v21, v24, v42
    v_fma_f32 v43, v21, v25, v43
    v_fma_f32 v44, v22, v24, v44
    v_fma_f32 v45, v22, v25, v45
    v_fma_f32 v46, v23, v24, v46
    v_fma_f32 v47, v23, v25, v47
    ds_read_b128 v[16:19], v7 offset:704
    ds_read_b128 v[20:23], v7 offset:720
    v_lshlrev_b32 v24, 16, v75
    v_and_b32 v25, 0xffff0000, v75
    s_waitcnt lgkmcnt(0)
    v_fma_f32 v32, v16, v24, v32
    v_fma_f32 v33, v16, v25, v33
    v_fma_f32 v34, v17, v24, v34
    v_fma_f32 v35, v17, v25, v35
    v_fma_f32 v36, v18, v24, v36
    v_fma_f32 v37, v18, v25, v37
    v_fma_f32 v38, v19, v24, v38
    v_fma_f32 v39, v19, v25, v39
    v_fma_f32 v40, v20, v24, v40
    v_fma_f32 v41, v20, v25, v41
    v_fma_f32 v42, v21, v24, v42
    v_fma_f32 v43, v21, v25, v43
    v_fma_f32 v44, v22, v24, v44
    v_fma_f32 v45, v22, v25, v45
    v_fma_f32 v46, v23, v24, v46
    v_fma_f32 v47, v23, v25, v47
    ds_read_b128 v[16:19], v7 offset:768
    ds_read_b128 v[20:23], v7 offset:784
    v_lshlrev_b32 v24, 16, v76
    v_and_b32 v25, 0xffff0000, v76
    s_waitcnt lgkmcnt(0)
    v_fma_f32 v32, v16, v24, v32
    v_fma_f32 v33, v16, v25, v33
    v_fma_f32 v34, v17, v24, v34
    v_fma_f32 v35, v17, v25, v35
    v_fma_f32 v36, v18, v24, v36
    v_fma_f32 v37, v18, v25, v37
    v_fma_f32 v38, v19, v24, v38
    v_fma_f32 v39, v19, v25, v39
    v_fma_f32 v40, v20, v24, v40
    v_fma_f32 v41, v20, v25, v41
    v_fma_f32 v42, v21, v24, v42
    v_fma_f32 v43, v21, v25, v43
    v_fma_f32 v44, v22, v24, v44
    v_fma_f32 v45, v22, v25, v45
    v_fma_f32 v46, v23, v24, v46
    v_fma_f32 v47, v23, v25, v47
    ds_read_b128 v[16:19], v7 offset:832
    ds_read_b128 v[20:23], v7 offset:848
    v_lshlrev_b32 v24, 16, v77
    v_and_b32 v25, 0xffff0000, v77
    s_waitcnt lgkmcnt(0)
    v_fma_f32 v32, v16, v24, v32
    v_fma_f32 v33, v16, v25, v33
    v_fma_f32 v34, v17, v24, v34
    v_fma_f32 v35, v17, v25, v35
    v_fma_f32 v36, v18, v24, v36
    v_fma_f32 v37, v18, v25, v37
    v_fma_f32 v38, v19, v24, v38
    v_fma_f32 v39, v19, v25, v39
    v_fma_f32 v40, v20, v24, v40
    v_fma_f32 v41, v20, v25, v41
    v_fma_f32 v42, v21, v24, v42
    v_fma_f32 v43, v21, v25, v43
    v_fma_f32 v44, v22, v24, v44
    v_fma_f32 v45, v22, v25, v45
    v_fma_f32 v46, v23, v24, v46
    v_fma_f32 v47, v23, v25, v47
    ds_read_b128 v[16:19], v7 offset:896
    ds_read_b128 v[20:23], v7 offset:912
    v_lshlrev_b32 v24, 16, v78
    v_and_b32 v25, 0xffff0000, v78
    s_waitcnt lgkmcnt(0)
    v_fma_f32 v32, v16, v24, v32
    v_fma_f32 v33, v16, v25, v33
    v_fma_f32 v34, v17, v24, v34
    v_fma_f32 v35, v17, v25, v35
    v_fma_f32 v36, v18, v24, v36
    v_fma_f32 v37, v18, v25, v37
    v_fma_f32 v38, v19, v24, v38
    v_fma_f32 v39, v19, v25, v39
    v_fma_f32 v40, v20, v24, v40
    v_fma_f32 v41, v20, v25, v41
    v_fma_f32 v42, v21, v24, v42
    v_fma_f32 v43, v21, v25, v43
    v_fma_f32 v44, v22, v24, v44
    v_fma_f32 v45, v22, v25, v45
    v_fma_f32 v46, v23, v24, v46
    v_fma_f32 v47, v23, v25, v47
    ds_read_b128 v[16:19], v7 offset:960
    ds_read_b128 v[20:23], v7 offset:976
    v_lshlrev_b32 v24, 16, v79
    v_and_b32 v25, 0xffff0000, v79
    s_waitcnt lgkmcnt(0)
    v_fma_f32 v32, v16, v24, v32
    v_fma_f32 v33, v16, v25, v33
    v_fma_f32 v34, v17, v24, v34
    v_fma_f32 v35, v17, v25, v35
    v_fma_f32 v36, v18, v24, v36
    v_fma_f32 v37, v18, v25, v37
    v_fma_f32 v38, v19, v24, v38
    v_fma_f32 v39, v19, v25, v39
    v_fma_f32 v40, v20, v24, v40
    v_fma_f32 v41, v20, v25, v41
    v_fma_f32 v42, v21, v24, v42
    v_fma_f32 v43, v21, v25, v43
    v_fma_f32 v44, v22, v24, v44
    v_fma_f32 v45, v22, v25, v45
    v_fma_f32 v46, v23, v24, v46
    v_fma_f32 v47, v23, v25, v47
    v_lshrrev_b32 v7, 5, v1
    v_lshl_add_u32 v7, v2, 1, v7
    v_lshlrev_b32 v7, 11, v7
    v_lshl_add_u32 v7, v4, 3, v7
    ds_write_b64 v7, v[32:33] offset:4096
    ds_write_b64 v7, v[34:35] offset:4352
    ds_write_b64 v7, v[36:37] offset:4608
    ds_write_b64 v7, v[38:39] offset:4864
    ds_write_b64 v7, v[40:41] offset:5120
    ds_write_b64 v7, v[42:43] offset:5376
    ds_write_b64 v7, v[44:45] offset:5632
    ds_write_b64 v7, v[46:47] offset:5888
    s_waitcnt lgkmcnt(0)
    s_barrier
    v_lshlrev_b32 v7, 3, v0
    ds_read_b64 v[16:17], v7 offset:4096
    ds_read_b64 v[18:19], v7 offset:6144
    ds_read_b64 v[20:21], v7 offset:8192
    ds_read_b64 v[22:23], v7 offset:10240
    ds_read_b64 v[24:25], v7 offset:12288
    ds_read_b64 v[26:27], v7 offset:14336
    ds_read_b64 v[28:29], v7 offset:16384
    ds_read_b64 v[30:31], v7 offset:18432
    s_waitcnt lgkmcnt(0)
    v_add_f32 v16, v16, v18
    v_add_f32 v17, v17, v19
    v_add_f32 v16, v16, v20
    v_add_f32 v17, v17, v21
    v_add_f32 v16, v16, v22
    v_add_f32 v17, v17, v23
    v_add_f32 v16, v16, v24
    v_add_f32 v17, v17, v25
    v_add_f32 v16, v16, v26
    v_add_f32 v17, v17, v27
    v_add_f32 v16, v16, v28
    v_add_f32 v17, v17, v29
    v_add_f32 v16, v16, v30
    v_add_f32 v17, v17, v31
    v_lshrrev_b32 v5, 5, v0
    v_lshlrev_b32 v5, 11, v5
    v_and_b32 v6, 31, v0
    v_lshl_add_u32 v5, v6, 3, v5
    s_lshl_b32 s24, s20, 14
    s_lshl_b32 s25, s21, 8
    s_add_u32 s24, s24, s25
    s_add_u32 s24, s24, 2097152
    buffer_store_dwordx2 v[16:17], v5, s[16:19], s24 offen
K3_END:
    s_endpgm
.globl k4_kernel
.p2align 8
.type k4_kernel,@function
k4_kernel:
    s_cmp_ge_u32 s2, 16
    s_cbranch_scc1 K4_END
    s_load_dwordx2 s[4:5], s[0:1], 0
    s_load_dwordx4 s[24:27], s[0:1], 72
    s_load_dwordx2 s[28:29], s[0:1], 96
    s_lshl_b32 s3, s2, 8
    v_add_u32 v1, s3, v0
    v_lshlrev_b32 v2, 2, v1
    s_waitcnt lgkmcnt(0)
    s_mov_b32 s8, s4
    s_mov_b32 s9, s5
    s_mov_b32 s10, 8192
    s_mov_b32 s11, 0x00020000
    s_mov_b32 s12, s24
    s_mov_b32 s13, s25
    s_mov_b32 s14, 1024
    s_mov_b32 s15, 0x00020000
    s_mov_b32 s16, s28
    s_mov_b32 s17, s29
    s_mov_b32 s18, 268435456
    s_mov_b32 s19, 0x00020000
    s_mov_b32 s20, s26
    s_mov_b32 s21, s27
    s_mov_b32 s22, 8192
    s_mov_b32 s23, 0x00020000
    s_mov_b32 s30, 2097152
    buffer_load_dword v16, v2, s[16:19], s30 offen
    s_add_u32 s30, s30, 16384
    buffer_load_dword v17, v2, s[16:19], s30 offen
    s_add_u32 s30, s30, 16384
    buffer_load_dword v18, v2, s[16:19], s30 offen
    s_add_u32 s30, s30, 16384
    buffer_load_dword v19, v2, s[16:19], s30 offen
    s_add_u32 s30, s30, 16384
    buffer_load_dword v20, v2, s[16:19], s30 offen
    s_add_u32 s30, s30, 16384
    buffer_load_dword v21, v2, s[16:19], s30 offen
    s_add_u32 s30, s30, 16384
    buffer_load_dword v22, v2, s[16:19], s30 offen
    s_add_u32 s30, s30, 16384
    buffer_load_dword v23, v2, s[16:19], s30 offen
    s_add_u32 s30, s30, 16384
    buffer_load_dword v24, v2, s[16:19], s30 offen
    s_add_u32 s30, s30, 16384
    buffer_load_dword v25, v2, s[16:19], s30 offen
    s_add_u32 s30, s30, 16384
    buffer_load_dword v26, v2, s[16:19], s30 offen
    s_add_u32 s30, s30, 16384
    buffer_load_dword v27, v2, s[16:19], s30 offen
    s_add_u32 s30, s30, 16384
    buffer_load_dword v28, v2, s[16:19], s30 offen
    s_add_u32 s30, s30, 16384
    buffer_load_dword v29, v2, s[16:19], s30 offen
    s_add_u32 s30, s30, 16384
    buffer_load_dword v30, v2, s[16:19], s30 offen
    s_add_u32 s30, s30, 16384
    buffer_load_dword v31, v2, s[16:19], s30 offen
    s_add_u32 s30, s30, 16384
    buffer_load_dword v32, v2, s[16:19], s30 offen
    s_add_u32 s30, s30, 16384
    buffer_load_dword v33, v2, s[16:19], s30 offen
    s_add_u32 s30, s30, 16384
    buffer_load_dword v34, v2, s[16:19], s30 offen
    s_add_u32 s30, s30, 16384
    buffer_load_dword v35, v2, s[16:19], s30 offen
    s_add_u32 s30, s30, 16384
    buffer_load_dword v36, v2, s[16:19], s30 offen
    s_add_u32 s30, s30, 16384
    buffer_load_dword v37, v2, s[16:19], s30 offen
    s_add_u32 s30, s30, 16384
    buffer_load_dword v38, v2, s[16:19], s30 offen
    s_add_u32 s30, s30, 16384
    buffer_load_dword v39, v2, s[16:19], s30 offen
    s_add_u32 s30, s30, 16384
    buffer_load_dword v40, v2, s[16:19], s30 offen
    s_add_u32 s30, s30, 16384
    buffer_load_dword v41, v2, s[16:19], s30 offen
    s_add_u32 s30, s30, 16384
    buffer_load_dword v42, v2, s[16:19], s30 offen
    s_add_u32 s30, s30, 16384
    buffer_load_dword v43, v2, s[16:19], s30 offen
    s_add_u32 s30, s30, 16384
    buffer_load_dword v44, v2, s[16:19], s30 offen
    s_add_u32 s30, s30, 16384
    buffer_load_dword v45, v2, s[16:19], s30 offen
    s_add_u32 s30, s30, 16384
    buffer_load_dword v46, v2, s[16:19], s30 offen
    s_add_u32 s30, s30, 16384
    buffer_load_dword v47, v2, s[16:19], s30 offen
    s_add_u32 s30, s30, 16384
    buffer_load_dword v48, v2, s[16:19], s30 offen
    s_add_u32 s30, s30, 16384
    buffer_load_dword v49, v2, s[16:19], s30 offen
    s_add_u32 s30, s30, 16384
    buffer_load_dword v50, v2, s[16:19], s30 offen
    s_add_u32 s30, s30, 16384
    buffer_load_dword v51, v2, s[16:19], s30 offen
    s_add_u32 s30, s30, 16384
    buffer_load_dword v52, v2, s[16:19], s30 offen
    s_add_u32 s30, s30, 16384
    buffer_load_dword v53, v2, s[16:19], s30 offen
    s_add_u32 s30, s30, 16384
    buffer_load_dword v54, v2, s[16:19], s30 offen
    s_add_u32 s30, s30, 16384
    buffer_load_dword v55, v2, s[16:19], s30 offen
    s_add_u32 s30, s30, 16384
    buffer_load_dword v56, v2, s[16:19], s30 offen
    s_add_u32 s30, s30, 16384
    buffer_load_dword v57, v2, s[16:19], s30 offen
    s_add_u32 s30, s30, 16384
    buffer_load_dword v58, v2, s[16:19], s30 offen
    s_add_u32 s30, s30, 16384
    buffer_load_dword v59, v2, s[16:19], s30 offen
    s_add_u32 s30, s30, 16384
    buffer_load_dword v60, v2, s[16:19], s30 offen
    s_add_u32 s30, s30, 16384
    buffer_load_dword v61, v2, s[16:19], s30 offen
    v_lshlrev_b32 v3, 1, v1
    v_and_b32 v4, 1023, v3
    buffer_load_ushort v5, v3, s[8:11], 0 offen
    buffer_load_ushort v6, v4, s[12:15], 0 offen
    s_waitcnt vmcnt(0)
    v_add_f32 v16, v16, v17
    v_add_f32 v16, v16, v18
    v_add_f32 v16, v16, v19
    v_add_f32 v16, v16, v20
    v_add_f32 v16, v16, v21
    v_add_f32 v16, v16, v22
    v_add_f32 v16, v16, v23
    v_add_f32 v16, v16, v24
    v_add_f32 v16, v16, v25
    v_add_f32 v16, v16, v26
    v_add_f32 v16, v16, v27
    v_add_f32 v16, v16, v28
    v_add_f32 v16, v16, v29
    v_add_f32 v16, v16, v30
    v_add_f32 v16, v16, v31
    v_add_f32 v16, v16, v32
    v_add_f32 v16, v16, v33
    v_add_f32 v16, v16, v34
    v_add_f32 v16, v16, v35
    v_add_f32 v16, v16, v36
    v_add_f32 v16, v16, v37
    v_add_f32 v16, v16, v38
    v_add_f32 v16, v16, v39
    v_add_f32 v16, v16, v40
    v_add_f32 v16, v16, v41
    v_add_f32 v16, v16, v42
    v_add_f32 v16, v16, v43
    v_add_f32 v16, v16, v44
    v_add_f32 v16, v16, v45
    v_add_f32 v16, v16, v46
    v_add_f32 v16, v16, v47
    v_add_f32 v48, v48, v49
    v_add_f32 v48, v48, v50
    v_add_f32 v48, v48, v51
    v_add_f32 v48, v48, v52
    v_add_f32 v48, v48, v53
    v_add_f32 v48, v48, v54
    v_add_f32 v48, v48, v55
    v_add_f32 v48, v48, v56
    v_add_f32 v48, v48, v57
    v_add_f32 v48, v48, v58
    v_add_f32 v48, v48, v59
    v_add_f32 v48, v48, v60
    v_add_f32 v48, v48, v61
    v_cvt_pk_bf16_f32 v16, v16, v16
    v_lshlrev_b32 v16, 16, v16
    v_cvt_pk_bf16_f32 v48, v48, v48
    v_lshlrev_b32 v48, 16, v48
    v_lshlrev_b32 v5, 16, v5
    v_lshlrev_b32 v6, 16, v6
    v_add_f32 v48, v48, v6
    v_cvt_pk_bf16_f32 v48, v48, v48
    v_lshlrev_b32 v48, 16, v48
    v_add_f32 v16, v16, v5
    v_cvt_pk_bf16_f32 v16, v16, v16
    v_lshlrev_b32 v16, 16, v16
    v_add_f32 v16, v16, v48
    v_cvt_pk_bf16_f32 v16, v16, v16
    buffer_store_short v16, v3, s[20:23], 0 offen
K4_END:
    s_endpgm
.section .rodata,"a"
.p2align 6
.amdhsa_kernel k1_kernel
  .amdhsa_next_free_vgpr 96
  .amdhsa_next_free_sgpr 64
  .amdhsa_accum_offset 96
  .amdhsa_group_segment_fixed_size 0
  .amdhsa_kernarg_size 104
  .amdhsa_user_sgpr_count 2
  .amdhsa_user_sgpr_kernarg_segment_ptr 1
  .amdhsa_system_sgpr_workgroup_id_x 1
.end_amdhsa_kernel
.p2align 6
.amdhsa_kernel k2_kernel
  .amdhsa_next_free_vgpr 104
  .amdhsa_next_free_sgpr 64
  .amdhsa_accum_offset 104
  .amdhsa_group_segment_fixed_size 0
  .amdhsa_kernarg_size 104
  .amdhsa_user_sgpr_count 2
  .amdhsa_user_sgpr_kernarg_segment_ptr 1
  .amdhsa_system_sgpr_workgroup_id_x 1
.end_amdhsa_kernel
.p2align 6
.amdhsa_kernel k3_kernel
  .amdhsa_next_free_vgpr 80
  .amdhsa_next_free_sgpr 64
  .amdhsa_accum_offset 80
  .amdhsa_group_segment_fixed_size 0
  .amdhsa_kernarg_size 104
  .amdhsa_user_sgpr_count 2
  .amdhsa_user_sgpr_kernarg_segment_ptr 1
  .amdhsa_system_sgpr_workgroup_id_x 1
.end_amdhsa_kernel
.p2align 6
.amdhsa_kernel k4_kernel
  .amdhsa_next_free_vgpr 64
  .amdhsa_next_free_sgpr 64
  .amdhsa_accum_offset 64
  .amdhsa_group_segment_fixed_size 0
  .amdhsa_kernarg_size 104
  .amdhsa_user_sgpr_count 2
  .amdhsa_user_sgpr_kernarg_segment_ptr 1
  .amdhsa_system_sgpr_workgroup_id_x 1
.end_amdhsa_kernel
```
